```python
import torch

def _softmax(x, axis=-1):
    return torch.softmax(x, dim=axis)
def _gelu(x):
    return torch.nn.functional.gelu(x, approximate="tanh")
def _silu(x):
    return torch.nn.functional.silu(x)
def _sigmoid(x):
    return torch.sigmoid(x)
def _layernorm(x, axis=-1, eps=1e-5):
    m = x.mean(dim=axis, keepdim=True)
    v = x.var(dim=axis, keepdim=True, unbiased=False)
    return (x - m) / torch.sqrt(v + eps)
def _scatter_add(tgt, idx, src, axis=0):
    return tgt.clone().index_add_(axis, idx, src)
def _segment_sum(src, seg, n):
    out = torch.zeros((n,) + src.shape[1:], dtype=src.dtype)
    return out.index_add_(0, seg, src)
def _pad(x, pw):
    flat = tuple(v for pair in reversed(pw) for v in pair)
    return torch.nn.functional.pad(x, flat)

kernel_name = 'standalone__modern_conv_block_convnext__vision'

def setup_inputs():

    _w = (lambda a: (lambda t: t.to(torch.bfloat16) if t.is_floating_point() else t)(torch.as_tensor(a)))
    H = W = 224
    C = 96
    K = 5
    return {
        "x": _w((lambda *s: torch.randn(*s, dtype=torch.bfloat16) * 0.05)(1, H, W, C)),
        "dw": _w((lambda *s: torch.randn(*s, dtype=torch.bfloat16) * 0.05)(K, K, C)),
        "w1": _w((lambda *s: torch.randn(*s, dtype=torch.bfloat16) * 0.05)(C, 4 * C)),
        "b1": _w((lambda *s: torch.randn(*s, dtype=torch.bfloat16) * 0.2)(4 * C)),
        "w2": _w((lambda *s: torch.randn(*s, dtype=torch.bfloat16) * 0.05)(4 * C, C)),
        "b2": _w((lambda *s: torch.randn(*s, dtype=torch.bfloat16) * 0.4)(C)),
        "gamma": _w((lambda *s: torch.randn(*s, dtype=torch.bfloat16) * 0.05)(C)),
    }

def reference(x, dw, w1, b1, w2, b2, gamma):
    B, H, W, C = x.shape
    K = dw.shape[0]
    pad = K // 2
    xp = _pad(x, ((0,0),(pad,pad),(pad,pad),(0,0)))
    out = torch.zeros_like(x)
    for i in range(K):
        for j in range(K):
            out = out + xp[:, i:i+H, j:j+W, :] * dw[i, j][None, None, None, :]
    h = _layernorm(out, axis=-1)
    h = torch.einsum('bhwc,ce->bhwe', h, w1) + b1
    h = _gelu(h)
    h = torch.einsum('bhwe,ec->bhwc', h, w2) + b2
    return x + gamma[None, None, None, :] * h
```

```asm
; @launch grid=(256,1,1) block=(256,1,1) lds=163584
.amdgcn_target "amdgcn-amd-amdhsa--gfx950"
.text
.globl standalone__modern_conv_block_convnext__vision_kernel
.p2align 12
.p2align 8
.type standalone__modern_conv_block_convnext__vision_kernel,@function
standalone__modern_conv_block_convnext__vision_kernel:
    s_cmp_ge_u32 s2, 256
    s_cbranch_scc1 L_end
    s_load_dwordx16 s[4:19], s[0:1], 0
    s_getpc_b64 s[52:53]
L_pc:
    s_lshr_b32 s3, s2, 3
    s_lshl_b32 s3, s3, 10
    v_and_b32_e64 v220, 7, v0
    v_lshl_add_u32 v220, v220, 7, s3
    v_min_u32 v220, L_end-L_pc, v220
    global_load_dword v101, v220, s[52:53]
    v_lshrrev_b32 v221, 6, v0
    v_and_b32_e64 v1, 63, v0
    v_readfirstlane_b32 s54, v221
    s_and_b32 s59, s2, 1
    s_lshl_b32 s59, s59, 3
    s_bfe_u32 s60, s2, 0x30003
    s_add_u32 s59, s59, s60
    s_mul_i32 s56, s59, 14
    s_bfe_u32 s59, s2, 0x20001
    s_lshl_b32 s59, s59, 2
    s_lshr_b32 s60, s2, 6
    s_add_u32 s59, s59, s60
    s_mul_i32 s57, s59, 14
    v_mul_u32_u24 v220, 43, v1
    v_lshrrev_b32 v220, 7, v220
    v_mul_u32_u24 v221, 3, v220
    v_sub_u32 v221, v1, v221
    v_and_b32 v222, 7, v220
    v_lshrrev_b32 v220, 3, v220
    v_mad_u32_u24 v220, v220, 5, v222
    v_cmp_le_u32 vcc, 3, v222
    v_mul_u32_u24 v220, 192, v220
    s_mul_i32 s59, s54, 48
    s_sub_u32 s59, s59, 576
    v_lshl_add_u32 v220, v221, 4, v220
    v_add_u32 v220, s59, v220
    v_bfrev_b32 v225, 1
    v_cndmask_b32 v240, v225, v220, vcc
    s_mul_i32 s60, s54, 56
    v_add_u32_e64 v221, s60, v1
    v_mul_u32_u24 v222, 171, v221
    v_lshrrev_b32 v222, 11, v222
    s_sub_u32 s61, s56, 2
    v_add_u32_e64 v223, s61, v222
    v_cmp_gt_u32 vcc, 224, v223
    v_cmp_gt_u32 s[78:79], 18, v222
    s_mul_i32 s62, s57, 43008
    s_mul_i32 s61, s61, 192
    s_add_u32 s62, s62, s61
    s_sub_u32 s62, s62, 86016
    s_and_b64 vcc, vcc, s[78:79]
    s_and_b32 vcc_hi, vcc_hi, 0xffffff
    v_lshl_add_u32 v96, v221, 4, s62
    s_mul_i32 s63, s54, 3072
    v_cndmask_b32 v96, v225, v96, vcc
    s_add_u32 s63, s63, 147456
    s_mov_b32 m0, s63
    s_mov_b32 s22, 9633792
    s_mov_b32 s23, 0x20000
    s_movk_i32 s26, 4800
    s_mov_b32 s27, 0x20000
    s_mov_b32 s44, 43008
    s_waitcnt lgkmcnt(0)
    s_mov_b32 s20, s4
    s_mov_b32 s21, s5
    buffer_load_dwordx4 a[0:3], v96, s[20:23], 0 offen
    v_add_u32_e64 v96, s44, v96
    buffer_load_dwordx4 a[4:7], v96, s[20:23], 0 offen
    v_add_u32_e64 v96, s44, v96
    buffer_load_dwordx4 a[8:11], v96, s[20:23], 0 offen
    v_add_u32_e64 v96, s44, v96
    buffer_load_dwordx4 a[12:15], v96, s[20:23], 0 offen
    v_add_u32_e64 v96, s44, v96
    s_mov_b32 s24, s6
    s_mov_b32 s25, s7
    s_mov_b32 exec_hi, 0xffff
    buffer_load_dwordx4 v240, s[24:27], 0 offen lds
    s_add_u32 m0, m0, 768
    v_add_u32 v240, 1920, v240
    buffer_load_dwordx4 v240, s[24:27], 0 offen lds
    s_add_u32 m0, m0, 768
    v_add_u32 v240, 1920, v240
    buffer_load_dwordx4 v240, s[24:27], 0 offen lds
    s_add_u32 m0, m0, 768
    v_add_u32 v240, 1920, v240
    buffer_load_dwordx4 v240, s[24:27], 0 offen lds
    s_mov_b32 exec_hi, -1
    buffer_load_dwordx4 a[16:19], v96, s[20:23], 0 offen
    v_add_u32_e64 v96, s44, v96
    s_lshl_b32 s52, s54, 3
    s_lshr_b32 s53, 0x30302818, s52
    s_and_b32 s53, s53, 0xff
    s_load_dwordx2 s[36:37], s[0:1], s53
    buffer_load_dwordx4 a[20:23], v96, s[20:23], 0 offen
    v_add_u32_e64 v96, s44, v96
    s_lshr_b32 s53, 0x20102010, s52
    s_and_b32 s53, s53, 0xff
    s_load_dwordx2 s[40:41], s[0:1], s53
    s_cmp_eq_u32 s54, 0
    buffer_load_dwordx4 a[24:27], v96, s[20:23], 0 offen
    v_add_u32_e64 v96, s44, v96
    s_movk_i32 s53, 192
    s_cselect_b32 s38, 768, s53
    s_mov_b32 s39, 0x20000
    s_min_u32 s45, s54, 2
    buffer_load_dwordx4 a[28:31], v96, s[20:23], 0 offen
    v_add_u32_e64 v96, s44, v96
    s_lshl_b32 s45, s45, 10
    s_add_u32 s45, s45, 159744
    s_mov_b32 s43, 0x20000
    s_mov_b32 s28, s8
    buffer_load_dwordx4 a[32:35], v96, s[20:23], 0 offen
    v_add_u32_e64 v96, s44, v96
    s_mov_b32 s29, s9
    s_mov_b32 s30, 73728
    s_mov_b32 s31, 0x20000
    s_mov_b32 s32, s12
    buffer_load_dwordx4 a[36:39], v96, s[20:23], 0 offen
    v_add_u32_e64 v96, s44, v96
    s_mov_b32 s33, s13
    s_mov_b32 s34, 73728
    s_mov_b32 s35, 0x20000
    s_mov_b32 s48, s18
    buffer_load_dwordx4 a[40:43], v96, s[20:23], 0 offen
    v_add_u32_e64 v96, s44, v96
    s_mov_b32 s49, s19
    s_mov_b32 s50, 9633792
    s_mov_b32 s51, 0x20000
    s_mov_b32 s10, 0xffff
    buffer_load_dwordx4 a[44:47], v96, s[20:23], 0 offen
    v_add_u32_e64 v96, s44, v96
    s_mov_b32 s11, 0xffff0000
    s_mul_i32 s14, s54, 3072
    s_mul_i32 s15, s54, 9216
    s_mul_i32 s16, s54, 18432
    s_add_u32 s17, s16, 5120
    s_add_u32 s3, s16, 10240
    v_mov_b64 v[244:245], 0
    v_mov_b64_e64 v[246:247], 0
    s_and_b32 s55, s54, 1
    s_xor_b32 s58, s55, 1
    v_mul_u32_u24 v223, 12, v222
    v_mfma_f32_32x32x16_bf16 a[192:207], v[244:247], v[244:247], 0
    v_sub_u32 v223, v221, v223
    v_subrev_u32 v224, 56, v1
    v_cmp_gt_u32 vcc, 56, v1
    v_mov_b32 v220, 18
    v_lshrrev_b32_e64 v228, 4, v1
    v_cndmask_b32 v223, v224, v223, vcc
    v_cndmask_b32 v222, v220, v222, vcc
    v_mfma_f32_32x32x16_bf16 a[208:223], v[244:247], v[244:247], 0
    v_mul_u32_u24 v223, 5776, v223
    v_lshl_add_u32 v223, v222, 3, v223
    v_add_u32 v95, 36864, v223
    v_and_b32_e64 v229, 3, v1
    v_bfe_u32 v233, v1, 2, 2
    v_lshrrev_b32 v231, 5, v1
    v_and_b32 v232, 1, v228
    v_mfma_f32_16x16x32_bf16 a[104:107], v[244:247], v[244:247], 0
    v_and_b32 v234, 31, v1
    v_lshlrev_b32 v14, 4, v1
    v_lshlrev_b32_e64 v235, 4, v231
    v_mul_u32_u24 v92, 0x5555, v229
    v_lshl_add_u32 v220, v228, 2, v233
    v_sub_u32 v221, v220, v229
    v_mul_u32_u24 v221, 48, v221
    v_mfma_f32_16x16x32_bf16 a[140:143], v[244:247], v[244:247], 0
    s_add_u32 s59, s63, 144
    v_add_u32_e64 v93, s59, v221
    v_mul_u32_u24 v220, 192, v220
    v_lshl_add_u32 v220, v229, 3, v220
    s_mul_i32 s59, s54, 6144
    s_add_u32 s60, s59, 86016
    v_add_u32_e64 v13, s60, v220
    v_mfma_f32_16x16x32_bf16 a[176:179], v[244:247], v[244:247], 0
    s_add_u32 s60, s59, 135168
    s_add_u32 s61, s59, 61440
    s_cmp_lt_u32 s54, 2
    s_cselect_b32 s60, s60, s61
    v_add_u32 v15, s60, v220
    v_add_u32 v9, s59, v14
    v_lshlrev_b32_e64 v220, 1, v229
    v_mfma_f32_32x32x16_bf16 v[116:131], v[244:247], v[244:247], 0
    v_add_u32 v220, v220, v228
    v_min_u32 v220, 8, v220
    v_mul_u32_u24 v221, 640, v233
    s_mul_i32 s59, s54, 17328
    s_add_u32 s59, s59, 36864
    v_lshl_add_u32 v220, v220, 4, v221
    v_add_u32_e64 v94, s59, v220
    v_mfma_f32_32x32x16_bf16 v[132:147], v[244:247], v[244:247], 0
    v_lshrrev_b32_e64 v220, 2, v234
    v_mul_u32_u24 v220, 768, v220
    v_lshl_add_u32 v220, v231, 6, v220
    v_lshl_add_u32 v255, v229, 4, v220
    v_min_u32 v220, 11, v1
    v_mul_u32_u24 v220, 5760, v220
    v_min_u32 v221, 31, v1
    v_mfma_f32_32x32x16_bf16 v[148:163], v[244:247], v[244:247], 0
    v_lshl_add_u32 v220, v221, 4, v220
    v_add_u32 v220, 42624, v220
    ds_write_b128 v220, v[244:247]
    s_mov_b32 s64, 0x409d30fc
    s_mov_b32 s65, 0x409d30fc
    s_mov_b32 s66, 1.0
    s_mov_b32 s67, 1.0
    v_mfma_f32_32x32x16_bf16 v[164:179], v[244:247], v[244:247], 0
    s_mov_b32 s68, 0x3c2aaaab
    s_mov_b32 s69, 0x3c2aaaab
    s_mov_b32 s72, 0x40088e99
    s_mov_b32 s73, 0x40088e99
    s_mov_b32 s74, 0x3eeff558
    s_mov_b32 s75, 0x3eeff558
    s_mov_b32 s76, 0x3727c5ac
    v_mfma_f32_32x32x16_bf16 v[180:195], v[244:247], v[244:247], 0
    s_mov_b32 s77, 0x3727c5ac
    s_mov_b32 s70, 0xd951c840
    s_mov_b32 s71, 0xb73a62
    s_mov_b32 s46, 0xdc985410
    s_mov_b32 s47, 0xba7632
    v_lshrrev_b32 v220, 1, v228
    v_and_b32 v220, v220, v228
    v_mfma_f32_32x32x16_bf16 v[196:211], v[244:247], v[244:247], 0
    v_lshl_add_u32 v221, v228, 2, v229
    v_sub_u32_e64 v221, v221, v220
    v_mad_u32_u24 v221, v233, 28, v221
    v_lshl_add_u32 v222, v229, 2, v228
    v_cmp_gt_u32 vcc, 14, v222
    v_mul_u32_u24 v221, 208, v221
    s_mul_i32 s59, s54, 48
    s_add_u32 s59, s59, 36864
    v_add_u32_e64 v221, s59, v221
    v_add_u32 v222, 77632, v14
    v_cndmask_b32 v97, v222, v221, vcc
    s_lshl_b32 s59, s54, 5
    v_add_u32_e64 v236, s59, v234
    s_lshr_b32 s59, s54, 1
    s_lshl_b32 s59, s59, 5
    s_add_u32 s59, s59, 128
    s_lshl_b32 s60, s55, 4
    v_xor_b32 v237, s60, v234
    v_add_u32 v237, s59, v237
    s_add_u32 s59, s59, s60
    v_and_b32 v238, 15, v1
    v_add_u32 v238, s59, v238
    v_add_u32 v221, 36864, v235
    s_movk_i32 s60, 208
    v_mad_u32_u24 v98, v236, s60, v221
    v_mad_u32_u24 v99, v237, s60, v221
    v_lshlrev_b32 v221, 4, v228
    v_add_u32 v221, 76800, v221
    v_mad_u32_u24 v100, v229, s60, v221
    s_mul_i32 s61, s57, 224
    s_add_u32 s61, s61, s56
    s_movk_i32 s62, 224
    v_mul_u32_u24 v221, 2341, v236
    v_lshrrev_b32 v221, 15, v221
    v_mul_u32_u24 v222, 14, v221
    v_sub_u32 v222, v236, v222
    v_lshlrev_b32 v222, 2, v222
    v_lshrrev_b64 v[224:225], v222, s[70:71]
    v_and_b32 v222, 15, v224
    v_lshlrev_b32 v221, 2, v221
    v_lshrrev_b64 v[224:225], v221, s[46:47]
    v_and_b32_e64 v221, 15, v224
    v_mad_u32_u24 v221, v221, s62, v222
    v_add_u32_e64 v221, s61, v221
    v_mul_u32_u24 v8, 192, v221
    v_mul_u32_u24 v221, 2341, v238
    v_lshrrev_b32 v221, 15, v221
    v_mul_u32_u24 v222, 14, v221
    v_sub_u32 v222, v238, v222
    v_lshlrev_b32 v222, 2, v222
    v_lshrrev_b64 v[224:225], v222, s[70:71]
    v_and_b32 v222, 15, v224
    v_lshlrev_b32 v221, 2, v221
    v_lshrrev_b64 v[224:225], v221, s[46:47]
    v_and_b32_e64 v221, 15, v224
    v_mad_u32_u24 v221, v221, s62, v222
    v_add_u32_e64 v221, s61, v221
    v_mul_u32_u24 v10, 192, v221
    s_lshl_b32 s59, s54, 2
    s_lshr_b32 s59, 0xb73a, s59
    s_and_b32 s59, s59, 15
    s_add_u32 s59, s59, s61
    s_add_u32 s59, s59, 2464
    s_mul_i32 s59, s59, 192
    v_lshl_add_u32 v221, v1, 3, s59
    v_cmp_gt_u32 vcc, 24, v1
    v_bfrev_b32 v225, 1
    v_add_u32 v8, v8, v235
    v_lshl_add_u32 v222, v232, 5, v235
    v_cndmask_b32 v11, v225, v221, vcc
    v_add_u32 v10, v10, v222
    v_lshlrev_b32_e64 v221, 5, v231
    v_add_u32 v12, 162816, v221
    s_lshl_b32 s59, s55, 6
    s_lshl_b32 s60, s58, 6
    v_lshlrev_b32_e64 v221, 1, v234
    v_add_u32 v221, 159744, v221
    v_add_u32 v6, s59, v221
    v_add_u32 v7, s60, v221
    v_lshlrev_b32_e64 v220, 6, v233
    v_lshl_add_u32 v220, v229, 3, v220
    v_lshl_add_u32 v221, v228, 10, v220
    s_lshr_b32 s61, s54, 1
    s_mul_i32 s61, s61, 12288
    s_lshl_b32 s59, s55, 9
    s_lshl_b32 s60, s58, 9
    s_add_u32 s61, s61, s59
    v_lshl_add_u32 v221, v232, 5, v221
    v_add_u32 v16, s61, v221
    v_xor_b32 v18, 32, v16
    v_lshl_add_u32 v220, v231, 10, v220
    v_lshl_add_u32 v220, v232, 5, v220
    v_add_u32 v2, s59, v220
    v_add_u32 v3, s60, v220
    v_and_b32 v220, 15, v1
    s_lshl_b32 s59, s54, 6
    s_add_u32 s59, s59, 159744
    v_lshl_add_u32 v17, v220, 1, s59
    v_lshl_add_u32 v220, v231, 2, v233
    v_mul_u32_u24 v220, 192, v220
    v_and_b32 v221, 1, v229
    v_lshrrev_b32 v222, 1, v229
    v_lshl_add_u32 v221, v221, 1, v222
    v_lshl_add_u32 v220, v221, 3, v220
    v_lshl_add_u32 v220, v232, 5, v220
    s_mul_i32 s59, s55, 6144
    s_add_u32 s59, s59, 110592
    s_mul_i32 s60, s58, 6144
    s_add_u32 s60, s60, 110592
    v_add_u32 v4, s59, v220
    v_add_u32 v5, s60, v220
    v_and_b32 v221, 1, v233
    v_lshrrev_b32 v222, 1, v233
    v_lshlrev_b32_e64 v222, 2, v222
    v_lshl_add_u32 v221, v221, 3, v222
    v_add_u32_e64 v221, v221, v229
    v_lshl_add_u32 v221, v232, 4, v221
    v_lshlrev_b32_e64 v221, 1, v221
    v_add_u32 v0, 160768, v221
    v_cmp_eq_u32 vcc, s55, v244
    v_mov_b32 v222, 161280
    v_mov_b32 v220, 0x3ef0
    v_cndmask_b32 v102, v222, v0, vcc
    v_mov_b32 v221, 0xb8ab
    v_cmp_eq_u32 vcc, 0, v231
    v_cmp_eq_u32 s[78:79], 0, v228
    v_mov_b32_e64 v223, 0
    v_cndmask_b32 v222, v221, v220, vcc
    v_accvgpr_write_b32 a196, v222
    v_cndmask_b32 v222, v221, v220, s[78:79]
    v_cndmask_b32 v222, v223, v222, vcc
    v_mov_b32 v221, 161280
    v_xor_b32 v224, v233, v232
    v_cmp_eq_u32 vcc, 0, v233
    v_cmp_eq_u32 s[78:79], 0, v224
    s_nop 0
    v_cndmask_b32 v220, v223, v222, vcc
    v_cndmask_b32 v106, v221, v100, s[78:79]
    v_accvgpr_write_b32 a200, v220
    v_cmp_eq_u32 vcc, 1, v233
    v_cmp_eq_u32 s[78:79], 1, v224
    s_nop 0
    v_cndmask_b32 v220, v223, v222, vcc
    v_cndmask_b32 v107, v221, v100, s[78:79]
    v_accvgpr_write_b32 a204, v220
    v_cmp_eq_u32 vcc, 2, v233
    v_cmp_eq_u32 s[78:79], 2, v224
    s_nop 0
    v_cndmask_b32 v220, v223, v222, vcc
    v_cndmask_b32 v108, v221, v100, s[78:79]
    v_accvgpr_write_b32 a208, v220
    v_cmp_eq_u32 vcc, 3, v233
    v_cmp_eq_u32 s[78:79], 3, v224
    s_nop 0
    v_cndmask_b32 v220, v223, v222, vcc
    v_cndmask_b32 v109, v221, v100, s[78:79]
    v_accvgpr_write_b32 a212, v220
    s_lshl_b32 s59, s54, 10
    s_add_u32 s59, s59, 147456
    v_add_u32_e64 v105, s59, v14
    v_bfrev_b32 v104, 1
    s_lshr_b32 s52, s2, 3
    s_lshl_b32 s52, s52, 1
    s_lshr_b32 s53, s54, 1
    s_add_u32 s52, s52, s53
    s_mul_i32 s52, s52, 1152
    s_mov_b32 s53, 9
    s_mov_b32 s42, s30
    v_lshl_add_u32 v103, v1, 7, s52
    v_cmp_gt_u32 s[18:19], s53, v1
    s_nop 1
    v_cndmask_b32 v103, v104, v103, s[18:19]
    s_waitcnt vmcnt(8) lgkmcnt(0)
    ds_read_b64_tr_b16 v[22:23], v93 offset:0
    ds_read_b64_tr_b16 v[26:27], v93 offset:768
    ds_read_b64_tr_b16 v[30:31], v93 offset:1536
    ds_read_b64_tr_b16 v[34:35], v93 offset:8
    ds_read_b64_tr_b16 v[38:39], v93 offset:776
    ds_read_b64_tr_b16 v[42:43], v93 offset:1544
    ds_read_b64_tr_b16 v[46:47], v93 offset:16
    ds_read_b64_tr_b16 v[50:51], v93 offset:784
    ds_read_b64_tr_b16 v[54:55], v93 offset:1552
    ds_read_b64_tr_b16 v[58:59], v93 offset:24
    ds_read_b64_tr_b16 v[62:63], v93 offset:792
    ds_read_b64_tr_b16 v[66:67], v93 offset:1560
    ds_read_b64_tr_b16 v[70:71], v93 offset:32
    ds_read_b64_tr_b16 v[74:75], v93 offset:800
    ds_read_b64_tr_b16 v[78:79], v93 offset:1568
    ds_read_b64_tr_b16 v[82:83], v93 offset:40
    ds_read_b64_tr_b16 v[86:87], v93 offset:808
    ds_read_b64_tr_b16 v[90:91], v93 offset:1576
    ds_write_b64 v95, a[0:1] offset:0
    ds_write_b64 v95, a[2:3] offset:2880
    buffer_load_dwordx4 a[48:51], v96, s[20:23], 0 offen
    v_add_u32_e64 v96, s44, v96
    ds_write_b64 v95, a[4:5] offset:160
    ds_write_b64 v95, a[6:7] offset:3040
    buffer_load_dwordx4 a[52:55], v96, s[20:23], 0 offen
    v_add_u32_e64 v96, s44, v96
    ds_write_b64 v95, a[8:9] offset:320
    ds_write_b64 v95, a[10:11] offset:3200
    buffer_load_dwordx4 a[56:59], v96, s[20:23], 0 offen
    v_add_u32_e64 v96, s44, v96
    ds_write_b64 v95, a[12:13] offset:480
    ds_write_b64 v95, a[14:15] offset:3360
    buffer_load_dwordx4 a[60:63], v96, s[20:23], 0 offen
    v_add_u32 v96, s44, v96
    s_waitcnt vmcnt(11)
    ds_write_b64 v95, a[16:17] offset:640
    ds_write_b64 v95, a[18:19] offset:3520
    buffer_load_dwordx4 a[64:67], v96, s[20:23], 0 offen
    v_add_u32 v96, s44, v96
    s_waitcnt vmcnt(11)
    ds_write_b64 v95, a[20:21] offset:800
    ds_write_b64 v95, a[22:23] offset:3680
    buffer_load_dwordx4 a[68:71], v96, s[20:23], 0 offen
    s_waitcnt vmcnt(11)
    ds_write_b64 v95, a[24:25] offset:960
    ds_write_b64 v95, a[26:27] offset:3840
    s_mov_b64 exec, 0
    s_cmp_eq_u32 s54, 1
    s_cbranch_scc1 L_pad3
    s_cmp_eq_u32 s54, 2
    s_cbranch_scc1 L_pad5
    s_cmp_eq_u32 s54, 3
    s_cbranch_scc1 L_body
    s_branch L_pad1
.p2align 12
.fill 896, 4, 0xbf800000
L_body:
    s_mov_b64 exec, -1
    s_waitcnt lgkmcnt(14)
    v_and_b32 v20, s10, v22
    v_and_b32 v21, s11, v22
    v_and_b32 v22, s10, v23
    v_and_b32 v23, s11, v23
    v_and_b32 v24, s10, v26
    v_and_b32 v25, s11, v26
    v_and_b32 v26, s10, v27
    s_waitcnt vmcnt(10)
    ds_write_b64 v95, a[28:29] offset:1120
    ds_write_b64 v95, a[30:31] offset:4000
    v_and_b32 v27, s11, v27
    v_and_b32 v28, s10, v30
    v_and_b32 v29, s11, v30
    v_and_b32 v30, s10, v31
    v_and_b32 v31, s11, v31
    v_and_b32 v32, s10, v34
    v_and_b32 v33, s11, v34
    s_waitcnt vmcnt(9)
    ds_write_b64 v95, a[32:33] offset:1280
    ds_write_b64 v95, a[34:35] offset:4160
    v_and_b32 v34, s10, v35
    v_and_b32 v35, s11, v35
    v_and_b32 v36, s10, v38
    v_and_b32 v37, s11, v38
    v_and_b32 v38, s10, v39
    v_and_b32 v39, s11, v39
    v_and_b32 v40, s10, v42
    s_waitcnt vmcnt(8)
    ds_write_b64 v95, a[36:37] offset:1440
    ds_write_b64 v95, a[38:39] offset:4320
    v_and_b32 v41, s11, v42
    v_and_b32 v42, s10, v43
    v_and_b32 v43, s11, v43
    v_and_b32 v44, s10, v46
    v_and_b32 v45, s11, v46
    v_and_b32 v46, s10, v47
    v_and_b32 v47, s11, v47
    s_waitcnt vmcnt(7)
    ds_write_b64 v95, a[40:41] offset:1600
    ds_write_b64 v95, a[42:43] offset:4480
    v_and_b32 v48, s10, v50
    v_and_b32 v49, s11, v50
    v_and_b32 v50, s10, v51
    v_and_b32 v51, s11, v51
    v_and_b32 v52, s10, v54
    v_and_b32 v53, s11, v54
    v_and_b32 v54, s10, v55
    s_waitcnt vmcnt(6)
    ds_write_b64 v95, a[44:45] offset:1760
    ds_write_b64 v95, a[46:47] offset:4640
    v_and_b32 v55, s11, v55
    v_and_b32 v56, s10, v58
    v_and_b32 v57, s11, v58
    v_and_b32 v58, s10, v59
    v_and_b32 v59, s11, v59
    v_and_b32 v60, s10, v62
    v_and_b32 v61, s11, v62
    s_waitcnt vmcnt(5)
    ds_write_b64 v95, a[48:49] offset:1920
    ds_write_b64 v95, a[50:51] offset:4800
    v_and_b32 v62, s10, v63
    v_and_b32 v63, s11, v63
    v_and_b32 v64, s10, v66
    v_and_b32 v65, s11, v66
    v_and_b32 v66, s10, v67
    v_and_b32 v67, s11, v67
    v_and_b32 v68, s10, v70
    s_waitcnt vmcnt(4)
    ds_write_b64 v95, a[52:53] offset:2080
    ds_write_b64 v95, a[54:55] offset:4960
    v_and_b32 v69, s11, v70
    v_and_b32 v70, s10, v71
    v_and_b32 v71, s11, v71
    v_and_b32 v72, s10, v74
    v_and_b32 v73, s11, v74
    v_and_b32 v74, s10, v75
    v_and_b32 v75, s11, v75
    s_waitcnt vmcnt(3)
    ds_write_b64 v95, a[56:57] offset:2240
    ds_write_b64 v95, a[58:59] offset:5120
    s_mov_b32 m0, s45
    buffer_load_dword v104, v103, s[40:43], 0 offen
    buffer_load_dwordx4 v14, s[36:39], 0 offen lds
    v_and_b32 v76, s10, v78
    v_and_b32 v77, s11, v78
    v_and_b32 v78, s10, v79
    v_and_b32 v79, s11, v79
    v_and_b32 v80, s10, v82
    v_and_b32 v81, s11, v82
    v_and_b32_e64 v82, s10, v83
    s_waitcnt vmcnt(4)
    ds_write_b64 v95, a[60:61] offset:2400
    ds_write_b64 v95, a[62:63] offset:5280
    v_and_b32 v83, s11, v83
    v_and_b32 v84, s10, v86
    v_and_b32 v85, s11, v86
    v_and_b32 v86, s10, v87
    v_and_b32 v87, s11, v87
    v_and_b32 v88, s10, v90
    v_and_b32 v89, s11, v90
    s_waitcnt vmcnt(3)
    ds_write_b64 v95, a[64:65] offset:2560
    ds_write_b64 v95, a[66:67] offset:5440
L_pad1:
    s_cbranch_execz L_pad2
    s_nop 0
    v_and_b32 v90, s10, v91
    v_and_b32_e64 v91, s11, v91
    s_waitcnt vmcnt(2)
    ds_write_b64 v95, a[68:69] offset:2720
    ds_write_b64 v95, a[70:71] offset:5600
    v_lshlrev_b32_e64 v103, 2, v1
    v_add_u32 v103, 160768, v103
    s_waitcnt lgkmcnt(0)
    s_barrier
    ds_read_b128 a[72:75], v94 offset:0
    ds_read_b128 a[76:79], v94 offset:160
    ds_read_b128 a[80:83], v94 offset:320
    ds_read_b128 a[84:87], v94 offset:480
    ds_read_b128 a[88:91], v94 offset:640
    ds_read_b128 a[92:95], v94 offset:800
    ds_read_b128 a[96:99], v94 offset:960
    ds_read_b128 a[100:103], v94 offset:1120
    s_waitcnt lgkmcnt(6)
    v_smfmac_f32_16x16x64_bf16 v[116:119], v[20:23], a[72:79], v92
    s_waitcnt lgkmcnt(5)
    s_add_u32 m0, s14, 0
    ds_read_b128 a[108:111], v94 offset:2880
    v_smfmac_f32_16x16x64_bf16 v[140:143], v[20:23], a[76:83], v92
    s_waitcnt lgkmcnt(5)
    ds_read_b128 a[112:115], v94 offset:3040
    v_smfmac_f32_16x16x64_bf16 v[164:167], v[20:23], a[80:87], v92
    s_waitcnt lgkmcnt(5)
    s_nop 0
    buffer_load_dwordx4 v255, s[28:31], s16 offen offset:0 lds
    v_smfmac_f32_16x16x64_bf16 v[188:191], v[20:23], a[84:91], v92
    ds_read_b128 a[116:119], v94 offset:3200
    v_smfmac_f32_16x16x64_bf16 v[116:119], v[24:27], a[80:87], v92
    ds_read_b128 a[120:123], v94 offset:3360
    v_smfmac_f32_16x16x64_bf16 v[140:143], v[24:27], a[84:91], v92
    s_waitcnt lgkmcnt(4)
    s_nop 0
    ds_read_b128 a[124:127], v94 offset:3520
    v_smfmac_f32_16x16x64_bf16 v[164:167], v[24:27], a[88:95], v92
    buffer_load_dwordx4 v255, s[28:31], s17 offen offset:1024 lds
    v_smfmac_f32_16x16x64_bf16 v[188:191], v[24:27], a[92:99], v92
    ds_read_b128 a[128:131], v94 offset:3680
    v_smfmac_f32_16x16x64_bf16 v[116:119], v[28:31], a[88:95], v92
    ds_read_b128 a[132:135], v94 offset:3840
    v_smfmac_f32_16x16x64_bf16 v[140:143], v[28:31], a[92:99], v92
    ds_read_b128 a[136:139], v94 offset:4000
    v_smfmac_f32_16x16x64_bf16 v[164:167], v[28:31], a[96:103], v92
    buffer_load_dwordx4 v255, s[28:31], s3 offen offset:2048 lds
    v_smfmac_f32_16x16x64_bf16 v[188:191], v[28:31], a[100:107], v92
    s_waitcnt lgkmcnt(3)
    s_nop 0
    v_smfmac_f32_16x16x64_bf16 v[120:123], v[32:35], a[108:115], v92
    s_add_u32 m0, s14, 12160
    ds_read_b128 a[144:147], v94 offset:5776
    v_smfmac_f32_16x16x64_bf16 v[144:147], v[32:35], a[112:119], v92
    ds_read_b128 a[148:151], v94 offset:5936
    v_smfmac_f32_16x16x64_bf16 v[168:171], v[32:35], a[116:123], v92
    buffer_load_dwordx4 v255, s[28:31], s16 offen offset:128 lds
    v_smfmac_f32_16x16x64_bf16 v[192:195], v[32:35], a[120:127], v92
    ds_read_b128 a[152:155], v94 offset:6096
    v_smfmac_f32_16x16x64_bf16 v[120:123], v[36:39], a[116:123], v92
    ds_read_b128 a[156:159], v94 offset:6256
    v_add_f32_e64 v228, v116, v117
    v_smfmac_f32_16x16x64_bf16 v[144:147], v[36:39], a[120:127], v92
    s_waitcnt lgkmcnt(4)
    ds_read_b128 a[160:163], v94 offset:6416
    v_add_f32 v212, v118, v119
    v_smfmac_f32_16x16x64_bf16 v[168:171], v[36:39], a[124:131], v92
    buffer_load_dwordx4 v255, s[28:31], s17 offen offset:1152 lds
    v_smfmac_f32_16x16x64_bf16 v[192:195], v[36:39], a[128:135], v92
    ds_read_b128 a[164:167], v94 offset:6576
    v_add_f32_e64 v229, v140, v141
    v_smfmac_f32_16x16x64_bf16 v[120:123], v[40:43], a[124:131], v92
    ds_read_b128 a[168:171], v94 offset:6736
    v_add_f32_e64 v213, v142, v143
    v_smfmac_f32_16x16x64_bf16 v[144:147], v[40:43], a[128:135], v92
    ds_read_b128 a[172:175], v94 offset:6896
    v_add_f32_e64 v230, v164, v165
    v_smfmac_f32_16x16x64_bf16 v[168:171], v[40:43], a[132:139], v92
    buffer_load_dwordx4 v255, s[28:31], s3 offen offset:2176 lds
    v_smfmac_f32_16x16x64_bf16 v[192:195], v[40:43], a[136:143], v92
    s_waitcnt lgkmcnt(3)
    v_add_f32 v214, v166, v167
    v_smfmac_f32_16x16x64_bf16 v[124:127], v[44:47], a[144:151], v92
    s_add_u32 m0, s14, 24320
    ds_read_b128 a[72:75], v94 offset:8656
    v_add_f32_e64 v231, v188, v189
    v_smfmac_f32_16x16x64_bf16 v[148:151], v[44:47], a[148:155], v92
    ds_read_b128 a[76:79], v94 offset:8816
    v_add_f32_e64 v215, v190, v191
    v_smfmac_f32_16x16x64_bf16 v[172:175], v[44:47], a[152:159], v92
    buffer_load_dwordx4 v255, s[28:31], s16 offen offset:256 lds
    v_smfmac_f32_16x16x64_bf16 v[196:199], v[44:47], a[156:163], v92
    ds_read_b128 a[80:83], v94 offset:8976
    v_add_f32_e64 v228, v228, v212
    v_smfmac_f32_16x16x64_bf16 v[124:127], v[48:51], a[152:159], v92
    ds_read_b128 a[84:87], v94 offset:9136
    v_add_f32_e64 v229, v229, v213
    v_smfmac_f32_16x16x64_bf16 v[148:151], v[48:51], a[156:163], v92
    s_waitcnt lgkmcnt(4)
    ds_read_b128 a[88:91], v94 offset:9296
    v_add_f32 v230, v230, v214
    v_smfmac_f32_16x16x64_bf16 v[172:175], v[48:51], a[160:167], v92
    buffer_load_dwordx4 v255, s[28:31], s17 offen offset:1280 lds
    v_smfmac_f32_16x16x64_bf16 v[196:199], v[48:51], a[164:171], v92
    ds_read_b128 a[92:95], v94 offset:9456
    v_add_f32_e64 v231, v231, v215
    v_smfmac_f32_16x16x64_bf16 v[124:127], v[52:55], a[160:167], v92
    ds_read_b128 a[96:99], v94 offset:9616
    v_add_f32_e64 v232, v120, v121
    v_smfmac_f32_16x16x64_bf16 v[148:151], v[52:55], a[164:171], v92
    ds_read_b128 a[100:103], v94 offset:9776
    v_add_f32_e64 v212, v122, v123
    v_smfmac_f32_16x16x64_bf16 v[172:175], v[52:55], a[168:175], v92
    buffer_load_dwordx4 v255, s[28:31], s3 offen offset:2304 lds
    v_smfmac_f32_16x16x64_bf16 v[196:199], v[52:55], a[172:179], v92
    s_waitcnt lgkmcnt(3)
    v_add_f32 v233, v144, v145
    v_smfmac_f32_16x16x64_bf16 v[128:131], v[56:59], a[72:79], v92
    s_add_u32 m0, s15, 110592
    s_add_u32 s62, s15, 0
    ds_read_b128 a[108:111], v94 offset:11552
    v_add_f32 v213, v146, v147
    v_smfmac_f32_16x16x64_bf16 v[152:155], v[56:59], a[76:83], v92
    ds_read_b128 a[112:115], v94 offset:11712
    v_add_f32_e64 v234, v168, v169
    v_smfmac_f32_16x16x64_bf16 v[176:179], v[56:59], a[80:87], v92
    buffer_load_dwordx4 v14, s[32:35], s62 offen offset:0 lds
    v_smfmac_f32_16x16x64_bf16 v[200:203], v[56:59], a[84:91], v92
    ds_read_b128 a[116:119], v94 offset:11872
    v_add_f32_e64 v214, v170, v171
    v_smfmac_f32_16x16x64_bf16 v[128:131], v[60:63], a[80:87], v92
    ds_read_b128 a[120:123], v94 offset:12032
    v_add_f32_e64 v235, v192, v193
    v_smfmac_f32_16x16x64_bf16 v[152:155], v[60:63], a[84:91], v92
    s_waitcnt lgkmcnt(4)
    ds_read_b128 a[124:127], v94 offset:12192
    v_add_f32 v215, v194, v195
    v_smfmac_f32_16x16x64_bf16 v[176:179], v[60:63], a[88:95], v92
    buffer_load_dwordx4 v14, s[32:35], s62 offen offset:1024 lds
    v_smfmac_f32_16x16x64_bf16 v[200:203], v[60:63], a[92:99], v92
    ds_read_b128 a[128:131], v94 offset:12352
    v_add_f32_e64 v232, v232, v212
    v_smfmac_f32_16x16x64_bf16 v[128:131], v[64:67], a[88:95], v92
    ds_read_b128 a[132:135], v94 offset:12512
    v_add_f32_e64 v233, v233, v213
    v_smfmac_f32_16x16x64_bf16 v[152:155], v[64:67], a[92:99], v92
    ds_read_b128 a[136:139], v94 offset:12672
    v_add_f32_e64 v234, v234, v214
    v_smfmac_f32_16x16x64_bf16 v[176:179], v[64:67], a[96:103], v92
    buffer_load_dwordx4 v14, s[32:35], s62 offen offset:2048 lds
    v_smfmac_f32_16x16x64_bf16 v[200:203], v[64:67], a[100:107], v92
    s_waitcnt lgkmcnt(3)
    v_add_f32 v235, v235, v215
    v_smfmac_f32_16x16x64_bf16 v[132:135], v[68:71], a[108:115], v92
    ds_read_b128 a[144:147], v94 offset:14432
    v_add_f32_e64 v236, v124, v125
    v_smfmac_f32_16x16x64_bf16 v[156:159], v[68:71], a[112:119], v92
    ds_read_b128 a[148:151], v94 offset:14592
    v_add_f32_e64 v212, v126, v127
    v_smfmac_f32_16x16x64_bf16 v[180:183], v[68:71], a[116:123], v92
    buffer_load_dwordx4 v14, s[32:35], s62 offen offset:3072 lds
    v_smfmac_f32_16x16x64_bf16 v[204:207], v[68:71], a[120:127], v92
    ds_read_b128 a[152:155], v94 offset:14752
    v_add_f32_e64 v237, v148, v149
    v_smfmac_f32_16x16x64_bf16 v[132:135], v[72:75], a[116:123], v92
    s_add_u32 m0, s15, 114688
    s_add_u32 s62, s15, 4096
    ds_read_b128 a[156:159], v94 offset:14912
    v_add_f32_e64 v213, v150, v151
    v_smfmac_f32_16x16x64_bf16 v[156:159], v[72:75], a[120:127], v92
    s_waitcnt lgkmcnt(4)
    ds_read_b128 a[160:163], v94 offset:15072
    v_add_f32 v238, v172, v173
    v_smfmac_f32_16x16x64_bf16 v[180:183], v[72:75], a[124:131], v92
    buffer_load_dwordx4 v14, s[32:35], s62 offen offset:0 lds
    v_smfmac_f32_16x16x64_bf16 v[204:207], v[72:75], a[128:135], v92
    ds_read_b128 a[164:167], v94 offset:15232
    v_add_f32_e64 v214, v174, v175
    v_smfmac_f32_16x16x64_bf16 v[132:135], v[76:79], a[124:131], v92
    ds_read_b128 a[168:171], v94 offset:15392
    v_add_f32_e64 v239, v196, v197
    v_smfmac_f32_16x16x64_bf16 v[156:159], v[76:79], a[128:135], v92
    ds_read_b128 a[172:175], v94 offset:15552
    v_add_f32_e64 v215, v198, v199
    v_smfmac_f32_16x16x64_bf16 v[180:183], v[76:79], a[132:139], v92
    buffer_load_dwordx4 v14, s[32:35], s62 offen offset:1024 lds
    v_smfmac_f32_16x16x64_bf16 v[204:207], v[76:79], a[136:143], v92
    s_waitcnt lgkmcnt(3)
    v_add_f32 v236, v236, v212
    v_smfmac_f32_16x16x64_bf16 v[136:139], v[80:83], a[144:151], v92
    v_add_f32_e64 v237, v237, v213
    v_smfmac_f32_16x16x64_bf16 v[160:163], v[80:83], a[148:155], v92
    v_add_f32_e64 v238, v238, v214
    v_smfmac_f32_16x16x64_bf16 v[184:187], v[80:83], a[152:159], v92
    buffer_load_dwordx4 v14, s[32:35], s62 offen offset:2048 lds
    v_smfmac_f32_16x16x64_bf16 v[208:211], v[80:83], a[156:163], v92
    v_add_f32_e64 v239, v239, v215
    v_smfmac_f32_16x16x64_bf16 v[136:139], v[84:87], a[152:159], v92
    v_add_f32_e64 v240, v128, v129
    v_smfmac_f32_16x16x64_bf16 v[160:163], v[84:87], a[156:163], v92
    s_waitcnt lgkmcnt(0)
    v_add_f32 v212, v130, v131
    v_smfmac_f32_16x16x64_bf16 v[184:187], v[84:87], a[160:167], v92
    buffer_load_dwordx4 v14, s[32:35], s62 offen offset:3072 lds
    v_smfmac_f32_16x16x64_bf16 v[208:211], v[84:87], a[164:171], v92
    v_add_f32_e64 v241, v152, v153
    v_smfmac_f32_16x16x64_bf16 v[136:139], v[88:91], a[160:167], v92
    s_add_u32 m0, s15, 118784
    s_add_u32 s62, s15, 8192
    v_add_f32_e64 v213, v154, v155
    v_smfmac_f32_16x16x64_bf16 v[160:163], v[88:91], a[164:171], v92
    v_add_f32_e64 v242, v176, v177
    v_smfmac_f32_16x16x64_bf16 v[184:187], v[88:91], a[168:175], v92
    buffer_load_dwordx4 v14, s[32:35], s62 offen offset:0 lds
    v_smfmac_f32_16x16x64_bf16 v[208:211], v[88:91], a[172:179], v92
    v_add_f32 v214, v178, v179
    v_add_f32 v243, v200, v201
    v_add_f32 v215, v202, v203
    v_add_f32 v240, v240, v212
    v_add_f32 v241, v241, v213
    v_add_f32 v242, v242, v214
    v_add_f32_e64 v243, v243, v215
    v_pk_mul_f32 v[20:21], v[116:117], v[116:117]
    v_pk_mul_f32 v[22:23], v[140:141], v[140:141]
    v_pk_mul_f32 v[24:25], v[164:165], v[164:165]
    v_pk_mul_f32 v[26:27], v[188:189], v[188:189]
    v_pk_fma_f32 v[20:21], v[118:119], v[118:119], v[20:21]
    v_pk_fma_f32 v[22:23], v[142:143], v[142:143], v[22:23]
    v_pk_fma_f32 v[24:25], v[166:167], v[166:167], v[24:25]
    v_pk_fma_f32 v[26:27], v[190:191], v[190:191], v[26:27]
    v_pk_fma_f32 v[20:21], v[120:121], v[120:121], v[20:21]
    v_pk_fma_f32 v[22:23], v[144:145], v[144:145], v[22:23]
    v_pk_fma_f32 v[24:25], v[168:169], v[168:169], v[24:25]
    v_pk_fma_f32 v[26:27], v[192:193], v[192:193], v[26:27]
    v_pk_fma_f32 v[20:21], v[122:123], v[122:123], v[20:21]
    v_pk_fma_f32 v[22:23], v[146:147], v[146:147], v[22:23]
    v_pk_fma_f32 v[24:25], v[170:171], v[170:171], v[24:25]
    v_pk_fma_f32 v[26:27], v[194:195], v[194:195], v[26:27]
    v_pk_fma_f32 v[20:21], v[124:125], v[124:125], v[20:21]
    v_pk_fma_f32 v[22:23], v[148:149], v[148:149], v[22:23]
    v_pk_fma_f32 v[24:25], v[172:173], v[172:173], v[24:25]
    v_pk_fma_f32 v[26:27], v[196:197], v[196:197], v[26:27]
    v_pk_fma_f32 v[20:21], v[126:127], v[126:127], v[20:21]
    v_pk_fma_f32 v[22:23], v[150:151], v[150:151], v[22:23]
    v_pk_fma_f32 v[24:25], v[174:175], v[174:175], v[24:25]
    v_pk_fma_f32 v[26:27], v[198:199], v[198:199], v[26:27]
    v_pk_fma_f32 v[20:21], v[128:129], v[128:129], v[20:21]
    v_pk_fma_f32 v[22:23], v[152:153], v[152:153], v[22:23]
    v_pk_fma_f32 v[24:25], v[176:177], v[176:177], v[24:25]
    v_pk_fma_f32 v[26:27], v[200:201], v[200:201], v[26:27]
    v_pk_fma_f32 v[20:21], v[130:131], v[130:131], v[20:21]
    v_pk_fma_f32 v[22:23], v[154:155], v[154:155], v[22:23]
    v_pk_fma_f32 v[24:25], v[178:179], v[178:179], v[24:25]
    v_pk_fma_f32 v[26:27], v[202:203], v[202:203], v[26:27]
    v_pk_fma_f32 v[20:21], v[132:133], v[132:133], v[20:21]
    v_pk_fma_f32 v[22:23], v[156:157], v[156:157], v[22:23]
    v_pk_fma_f32 v[24:25], v[180:181], v[180:181], v[24:25]
    v_pk_fma_f32 v[26:27], v[204:205], v[204:205], v[26:27]
    v_pk_fma_f32 v[20:21], v[134:135], v[134:135], v[20:21]
    v_pk_fma_f32 v[22:23], v[158:159], v[158:159], v[22:23]
    v_pk_fma_f32 v[24:25], v[182:183], v[182:183], v[24:25]
    v_pk_fma_f32 v[26:27], v[206:207], v[206:207], v[26:27]
    v_pk_fma_f32 v[20:21], v[136:137], v[136:137], v[20:21]
    v_pk_fma_f32 v[22:23], v[160:161], v[160:161], v[22:23]
    v_pk_fma_f32 v[24:25], v[184:185], v[184:185], v[24:25]
    v_pk_fma_f32 v[26:27], v[208:209], v[208:209], v[26:27]
    v_pk_fma_f32 v[20:21], v[138:139], v[138:139], v[20:21]
    v_pk_fma_f32 v[22:23], v[162:163], v[162:163], v[22:23]
    v_pk_fma_f32 v[24:25], v[186:187], v[186:187], v[24:25]
    v_pk_fma_f32 v[26:27], v[210:211], v[210:211], v[26:27]
    v_pk_add_f32 v[28:29], v[132:133], v[134:135]
    v_pk_add_f32 v[30:31], v[156:157], v[158:159]
    v_pk_add_f32 v[32:33], v[180:181], v[182:183]
    v_pk_add_f32 v[34:35], v[204:205], v[206:207]
    v_pk_add_f32 v[228:229], v[228:229], v[232:233]
    v_pk_add_f32 v[236:237], v[236:237], v[240:241]
    v_pk_add_f32 v[230:231], v[230:231], v[234:235]
    v_pk_add_f32 v[238:239], v[238:239], v[242:243]
    v_pk_add_f32 v[28:29], v[28:29], v[136:137]
    v_pk_add_f32 v[30:31], v[30:31], v[160:161]
    v_pk_add_f32 v[32:33], v[32:33], v[184:185]
    v_pk_add_f32 v[34:35], v[34:35], v[208:209]
    v_pk_add_f32 v[28:29], v[28:29], v[138:139]
    v_pk_add_f32 v[30:31], v[30:31], v[162:163]
    v_pk_add_f32 v[32:33], v[32:33], v[186:187]
    v_pk_add_f32 v[34:35], v[34:35], v[210:211]
    v_pk_add_f32 v[228:229], v[228:229], v[236:237]
    v_pk_add_f32 v[230:231], v[230:231], v[238:239]
    v_add_f32 v222, v20, v21
    v_add_f32 v232, v28, v29
    v_add_f32 v223, v22, v23
    v_add_f32 v233, v30, v31
    v_add_f32 v226, v24, v25
    v_add_f32 v234, v32, v33
    v_add_f32 v227, v26, v27
    v_add_f32 v235, v34, v35
    v_pk_add_f32 v[220:221], v[228:229], v[232:233]
    v_pk_add_f32 v[224:225], v[230:231], v[234:235]
    ds_write_b128 v105, v[220:223]
    ds_write_b128 v105, v[224:227] offset:4096
    v_add_u32 v105, 147456, v14
    s_waitcnt vmcnt(9) lgkmcnt(0)
    s_barrier
    ds_read_b128 v[220:223], v105 offset:0
    ds_read_b128 v[224:227], v105 offset:1024
    ds_read_b128 v[228:231], v105 offset:2048
    ds_read_b128 v[232:235], v105 offset:3072
    ds_read_b128 v[236:239], v105 offset:4096
    ds_read_b128 v[240:243], v105 offset:5120
    ds_read_b128 v[244:247], v105 offset:6144
    ds_read_b128 v[248:251], v105 offset:7168
    ds_read_u16 a192, v6 offset:0
    ds_read_b64_tr_b16 a[0:1], v2 offset:0
    ds_read_b64_tr_b16 a[2:3], v2 offset:256
    ds_read_b64_tr_b16 a[4:5], v2 offset:2048
    ds_read_b64_tr_b16 a[6:7], v2 offset:2304
    ds_read_b64_tr_b16 a[8:9], v2 offset:4096
    ds_read_b64_tr_b16 a[10:11], v2 offset:4352
    s_waitcnt lgkmcnt(11)
    v_pk_add_f32 v[220:221], v[220:221], v[224:225]
    v_pk_add_f32 v[222:223], v[222:223], v[226:227]
    v_pk_add_f32 v[228:229], v[228:229], v[232:233]
    v_pk_add_f32 v[230:231], v[230:231], v[234:235]
    s_waitcnt lgkmcnt(7)
    ds_read_b64_tr_b16 a[12:13], v2 offset:6144
    ds_read_b64_tr_b16 a[14:15], v2 offset:6400
    ds_read_b64_tr_b16 a[16:17], v2 offset:8192
    ds_read_b64_tr_b16 a[18:19], v2 offset:8448
    ds_read_b64_tr_b16 a[20:21], v2 offset:10240
    ds_read_b64_tr_b16 a[22:23], v2 offset:10496
    ds_read_u16 a216, v102 offset:0
    ds_read_u16 a218, v102 offset:64
    ds_read_u16 a220, v102 offset:128
    ds_read_b32 v37, v103 offset:1024
    ds_read_b32 v39, v103
    v_pk_add_f32 v[236:237], v[236:237], v[240:241]
    v_pk_add_f32 v[238:239], v[238:239], v[242:243]
    v_pk_add_f32 v[244:245], v[244:245], v[248:249]
    v_pk_add_f32 v[246:247], v[246:247], v[250:251]
    v_pk_add_f32 v[220:221], v[220:221], v[228:229]
    v_pk_add_f32 v[236:237], v[236:237], v[244:245]
    v_pk_add_f32 v[222:223], v[222:223], v[230:231]
    v_pk_add_f32 v[238:239], v[238:239], v[246:247]
    v_pk_mul_f32 v[220:221], v[220:221], s[68:69]
    v_pk_mul_f32 v[236:237], v[236:237], s[68:69]
    v_pk_mul_f32 v[222:223], v[222:223], s[68:69]
    v_pk_mul_f32 v[238:239], v[238:239], s[68:69]
    v_pk_fma_f32 v[222:223], v[220:221], v[220:221], v[222:223] neg_lo:[1,0,0] neg_hi:[1,0,0]
    v_pk_fma_f32 v[238:239], v[236:237], v[236:237], v[238:239] neg_lo:[1,0,0] neg_hi:[1,0,0]
    v_max_f32 v222, 0, v222
    v_max_f32 v238, 0, v238
    v_max_f32 v223, 0, v223
    v_max_f32 v239, 0, v239
    v_pk_add_f32 v[222:223], v[222:223], s[76:77]
    v_pk_add_f32 v[238:239], v[238:239], s[76:77]
    v_rsq_f32 v222, v222
    v_rsq_f32 v238, v238
    v_rsq_f32 v223, v223
    v_rsq_f32 v239, v239
    v_pk_mul_f32 v[222:223], v[222:223], s[74:75]
    v_pk_mul_f32 v[238:239], v[238:239], s[74:75]
    v_pk_mul_f32 v[220:221], v[220:221], v[222:223] neg_lo:[1,0] neg_hi:[1,0]
    v_pk_mul_f32 v[236:237], v[236:237], v[238:239] neg_lo:[1,0] neg_hi:[1,0]
    v_pk_fma_f32 v[116:117], v[116:117], v[222:223], v[220:221] op_sel:[0,0,0] op_sel_hi:[1,0,0]
    v_pk_fma_f32 v[118:119], v[118:119], v[222:223], v[220:221] op_sel:[0,0,0] op_sel_hi:[1,0,0]
    v_pk_fma_f32 v[120:121], v[120:121], v[222:223], v[220:221] op_sel:[0,0,0] op_sel_hi:[1,0,0]
    v_pk_fma_f32 v[122:123], v[122:123], v[222:223], v[220:221] op_sel:[0,0,0] op_sel_hi:[1,0,0]
    v_cvt_pk_bf16_f32 v116, v116, v117
    v_cvt_pk_bf16_f32 v117, v118, v119
    v_cvt_pk_bf16_f32 v118, v120, v121
    v_cvt_pk_bf16_f32 v119, v122, v123
    ds_write_b128 v97, v[116:119] offset:0
    v_pk_fma_f32 v[124:125], v[124:125], v[222:223], v[220:221] op_sel:[0,0,0] op_sel_hi:[1,0,0]
    v_pk_fma_f32 v[126:127], v[126:127], v[222:223], v[220:221] op_sel:[0,0,0] op_sel_hi:[1,0,0]
    v_pk_fma_f32 v[128:129], v[128:129], v[222:223], v[220:221] op_sel:[0,0,0] op_sel_hi:[1,0,0]
    v_pk_fma_f32 v[130:131], v[130:131], v[222:223], v[220:221] op_sel:[0,0,0] op_sel_hi:[1,0,0]
    v_cvt_pk_bf16_f32 v124, v124, v125
    v_cvt_pk_bf16_f32 v125, v126, v127
    v_cvt_pk_bf16_f32 v126, v128, v129
    v_cvt_pk_bf16_f32 v127, v130, v131
    ds_write_b128 v97, v[124:127] offset:16
    v_pk_fma_f32 v[132:133], v[132:133], v[222:223], v[220:221] op_sel:[0,0,0] op_sel_hi:[1,0,0]
    v_pk_fma_f32 v[134:135], v[134:135], v[222:223], v[220:221] op_sel:[0,0,0] op_sel_hi:[1,0,0]
    v_pk_fma_f32 v[136:137], v[136:137], v[222:223], v[220:221] op_sel:[0,0,0] op_sel_hi:[1,0,0]
    v_pk_fma_f32 v[138:139], v[138:139], v[222:223], v[220:221] op_sel:[0,0,0] op_sel_hi:[1,0,0]
    v_cvt_pk_bf16_f32 v132, v132, v133
    v_cvt_pk_bf16_f32 v133, v134, v135
    v_cvt_pk_bf16_f32 v134, v136, v137
    v_cvt_pk_bf16_f32 v135, v138, v139
    ds_write_b128 v97, v[132:135] offset:32
    v_pk_fma_f32 v[140:141], v[140:141], v[222:223], v[220:221] op_sel:[0,1,1] op_sel_hi:[1,1,1]
    v_pk_fma_f32 v[142:143], v[142:143], v[222:223], v[220:221] op_sel:[0,1,1] op_sel_hi:[1,1,1]
    v_pk_fma_f32 v[144:145], v[144:145], v[222:223], v[220:221] op_sel:[0,1,1] op_sel_hi:[1,1,1]
    v_pk_fma_f32 v[146:147], v[146:147], v[222:223], v[220:221] op_sel:[0,1,1] op_sel_hi:[1,1,1]
    v_cvt_pk_bf16_f32 v140, v140, v141
    v_cvt_pk_bf16_f32 v141, v142, v143
    v_cvt_pk_bf16_f32 v142, v144, v145
    v_cvt_pk_bf16_f32 v143, v146, v147
    ds_write_b128 v97, v[140:143] offset:2912
    v_pk_fma_f32 v[148:149], v[148:149], v[222:223], v[220:221] op_sel:[0,1,1] op_sel_hi:[1,1,1]
    v_pk_fma_f32 v[150:151], v[150:151], v[222:223], v[220:221] op_sel:[0,1,1] op_sel_hi:[1,1,1]
    v_pk_fma_f32 v[152:153], v[152:153], v[222:223], v[220:221] op_sel:[0,1,1] op_sel_hi:[1,1,1]
    v_pk_fma_f32 v[154:155], v[154:155], v[222:223], v[220:221] op_sel:[0,1,1] op_sel_hi:[1,1,1]
    v_cvt_pk_bf16_f32 v148, v148, v149
    v_cvt_pk_bf16_f32 v149, v150, v151
    v_cvt_pk_bf16_f32 v150, v152, v153
    v_cvt_pk_bf16_f32 v151, v154, v155
    ds_write_b128 v97, v[148:151] offset:2928
    v_pk_fma_f32 v[156:157], v[156:157], v[222:223], v[220:221] op_sel:[0,1,1] op_sel_hi:[1,1,1]
    v_pk_fma_f32 v[158:159], v[158:159], v[222:223], v[220:221] op_sel:[0,1,1] op_sel_hi:[1,1,1]
    v_pk_fma_f32 v[160:161], v[160:161], v[222:223], v[220:221] op_sel:[0,1,1] op_sel_hi:[1,1,1]
    v_pk_fma_f32 v[162:163], v[162:163], v[222:223], v[220:221] op_sel:[0,1,1] op_sel_hi:[1,1,1]
    v_cvt_pk_bf16_f32 v156, v156, v157
    v_cvt_pk_bf16_f32 v157, v158, v159
    v_cvt_pk_bf16_f32 v158, v160, v161
    v_cvt_pk_bf16_f32 v159, v162, v163
    ds_write_b128 v97, v[156:159] offset:2944
    v_pk_fma_f32 v[164:165], v[164:165], v[238:239], v[236:237] op_sel:[0,0,0] op_sel_hi:[1,0,0]
    v_pk_fma_f32 v[166:167], v[166:167], v[238:239], v[236:237] op_sel:[0,0,0] op_sel_hi:[1,0,0]
    v_pk_fma_f32 v[168:169], v[168:169], v[238:239], v[236:237] op_sel:[0,0,0] op_sel_hi:[1,0,0]
    v_pk_fma_f32 v[170:171], v[170:171], v[238:239], v[236:237] op_sel:[0,0,0] op_sel_hi:[1,0,0]
    v_cvt_pk_bf16_f32 v164, v164, v165
    v_cvt_pk_bf16_f32 v165, v166, v167
    v_cvt_pk_bf16_f32 v166, v168, v169
    v_cvt_pk_bf16_f32 v167, v170, v171
    ds_write_b128 v97, v[164:167] offset:23296
    v_pk_fma_f32 v[172:173], v[172:173], v[238:239], v[236:237] op_sel:[0,0,0] op_sel_hi:[1,0,0]
    v_pk_fma_f32 v[174:175], v[174:175], v[238:239], v[236:237] op_sel:[0,0,0] op_sel_hi:[1,0,0]
    v_pk_fma_f32 v[176:177], v[176:177], v[238:239], v[236:237] op_sel:[0,0,0] op_sel_hi:[1,0,0]
    v_pk_fma_f32 v[178:179], v[178:179], v[238:239], v[236:237] op_sel:[0,0,0] op_sel_hi:[1,0,0]
    v_cvt_pk_bf16_f32 v172, v172, v173
    v_cvt_pk_bf16_f32 v173, v174, v175
    v_cvt_pk_bf16_f32 v174, v176, v177
    v_cvt_pk_bf16_f32 v175, v178, v179
    ds_write_b128 v97, v[172:175] offset:23312
    v_pk_fma_f32 v[180:181], v[180:181], v[238:239], v[236:237] op_sel:[0,0,0] op_sel_hi:[1,0,0]
    v_pk_fma_f32 v[182:183], v[182:183], v[238:239], v[236:237] op_sel:[0,0,0] op_sel_hi:[1,0,0]
    v_pk_fma_f32 v[184:185], v[184:185], v[238:239], v[236:237] op_sel:[0,0,0] op_sel_hi:[1,0,0]
    v_pk_fma_f32 v[186:187], v[186:187], v[238:239], v[236:237] op_sel:[0,0,0] op_sel_hi:[1,0,0]
    v_cvt_pk_bf16_f32 v180, v180, v181
    v_cvt_pk_bf16_f32 v181, v182, v183
    v_cvt_pk_bf16_f32 v182, v184, v185
    v_cvt_pk_bf16_f32 v183, v186, v187
    ds_write_b128 v97, v[180:183] offset:23328
    v_pk_fma_f32 v[188:189], v[188:189], v[238:239], v[236:237] op_sel:[0,1,1] op_sel_hi:[1,1,1]
    v_pk_fma_f32 v[190:191], v[190:191], v[238:239], v[236:237] op_sel:[0,1,1] op_sel_hi:[1,1,1]
    v_pk_fma_f32 v[192:193], v[192:193], v[238:239], v[236:237] op_sel:[0,1,1] op_sel_hi:[1,1,1]
    v_pk_fma_f32 v[194:195], v[194:195], v[238:239], v[236:237] op_sel:[0,1,1] op_sel_hi:[1,1,1]
    v_cvt_pk_bf16_f32 v188, v188, v189
    v_cvt_pk_bf16_f32 v189, v190, v191
    v_cvt_pk_bf16_f32 v190, v192, v193
    v_cvt_pk_bf16_f32 v191, v194, v195
    ds_write_b128 v97, v[188:191] offset:26208
    v_pk_fma_f32 v[196:197], v[196:197], v[238:239], v[236:237] op_sel:[0,1,1] op_sel_hi:[1,1,1]
    v_pk_fma_f32 v[198:199], v[198:199], v[238:239], v[236:237] op_sel:[0,1,1] op_sel_hi:[1,1,1]
    v_pk_fma_f32 v[200:201], v[200:201], v[238:239], v[236:237] op_sel:[0,1,1] op_sel_hi:[1,1,1]
    v_pk_fma_f32 v[202:203], v[202:203], v[238:239], v[236:237] op_sel:[0,1,1] op_sel_hi:[1,1,1]
    v_cvt_pk_bf16_f32 v196, v196, v197
    v_cvt_pk_bf16_f32 v197, v198, v199
    v_cvt_pk_bf16_f32 v198, v200, v201
    v_cvt_pk_bf16_f32 v199, v202, v203
    ds_write_b128 v97, v[196:199] offset:26224
    v_pk_fma_f32 v[204:205], v[204:205], v[238:239], v[236:237] op_sel:[0,1,1] op_sel_hi:[1,1,1]
    v_pk_fma_f32 v[206:207], v[206:207], v[238:239], v[236:237] op_sel:[0,1,1] op_sel_hi:[1,1,1]
    v_pk_fma_f32 v[208:209], v[208:209], v[238:239], v[236:237] op_sel:[0,1,1] op_sel_hi:[1,1,1]
    v_pk_fma_f32 v[210:211], v[210:211], v[238:239], v[236:237] op_sel:[0,1,1] op_sel_hi:[1,1,1]
    v_cvt_pk_bf16_f32 v204, v204, v205
    v_cvt_pk_bf16_f32 v205, v206, v207
    v_cvt_pk_bf16_f32 v206, v208, v209
    v_cvt_pk_bf16_f32 v207, v210, v211
    ds_write_b128 v97, v[204:207] offset:26240
    s_waitcnt lgkmcnt(0)
    s_barrier
    ds_read_b128 a[72:75], v98 offset:0
    ds_read_b128 a[76:79], v98 offset:32
    ds_read_b128 a[80:83], v98 offset:64
    ds_read_b128 a[84:87], v98 offset:96
    ds_read_b128 a[88:91], v98 offset:128
    ds_read_b128 a[92:95], v98 offset:160
    ds_read_b128 a[96:99], v99 offset:0
    ds_read_b128 a[100:103], v99 offset:32
    ds_read_b128 a[104:107], v99 offset:64
    ds_read_b128 a[108:111], v99 offset:96
    ds_read_b128 a[112:115], v99 offset:128
    ds_read_b128 a[116:119], v99 offset:160
    v_mfma_f32_32x32x16_bf16 v[116:131], a[192:195], a[196:199], 0
    s_waitcnt lgkmcnt(11)
    v_lshlrev_b32 v36, 16, v37
    v_and_b32 v37, s11, v37
    v_lshlrev_b32 v38, 16, v39
    v_mfma_f32_32x32x16_bf16 v[116:131], a[0:3], a[72:75], v[116:131]
    s_waitcnt lgkmcnt(10)
    ds_read_b128 a[120:123], v106 offset:0
    ds_read_b128 a[124:127], v106 offset:64
    v_and_b32 v39, s11, v39
    v_mfma_f32_32x32x16_bf16 v[116:131], a[4:7], a[76:79], v[116:131]
    s_waitcnt lgkmcnt(11)
    ds_read_b128 a[128:131], v106 offset:128
    ds_read_b128 a[132:135], v107 offset:0
    v_lshlrev_b32 v103, 3, v1
    v_mfma_f32_32x32x16_bf16 v[116:131], a[8:11], a[80:83], v[116:131]
    s_waitcnt lgkmcnt(12)
    ds_read_b128 a[136:139], v107 offset:64
    ds_read_b128 a[140:143], v107 offset:128
    v_mul_f32 v38, v38, v36
    v_mfma_f32_32x32x16_bf16 v[116:131], a[12:15], a[84:87], v[116:131]
    s_waitcnt lgkmcnt(13)
    ds_read_b128 a[144:147], v108 offset:0
    ds_read_b128 a[148:151], v108 offset:64
    v_mul_f32 v39, v39, v37
    v_mfma_f32_32x32x16_bf16 v[116:131], a[16:19], a[88:91], v[116:131]
    s_waitcnt lgkmcnt(14)
    ds_read_b128 a[152:155], v108 offset:128
    ds_read_b128 a[156:159], v109 offset:0
    v_mul_f32 v36, s72, v36
    v_mfma_f32_32x32x16_bf16 v[116:131], a[20:23], a[92:95], v[116:131]
    ds_read_b128 a[160:163], v109 offset:64
    ds_read_b128 a[164:167], v109 offset:128
    v_mul_f32_e64 v37, s72, v37
    v_add_u32 v103, 162816, v103
    s_mov_b32 exec_hi, 0xffff
    ds_write_b64 v103, v[36:37]
    ds_write_b64 v103, v[38:39] offset:384
    s_mov_b32 exec_hi, -1
    s_nop 5
    v_pk_fma_f32 v[164:165], v[116:117], v[116:117], s[64:65]
    v_pk_fma_f32 v[166:167], v[118:119], v[118:119], s[64:65]
    v_pk_fma_f32 v[168:169], v[120:121], v[120:121], s[64:65]
    v_pk_fma_f32 v[170:171], v[122:123], v[122:123], s[64:65]
    v_pk_fma_f32 v[172:173], v[124:125], v[124:125], s[64:65]
    v_pk_fma_f32 v[174:175], v[126:127], v[126:127], s[64:65]
    v_pk_fma_f32 v[176:177], v[128:129], v[128:129], s[64:65]
    v_pk_fma_f32 v[178:179], v[130:131], v[130:131], s[64:65]
    v_pk_mul_f32 v[164:165], v[164:165], v[116:117] neg_lo:[1,0] neg_hi:[1,0]
    v_pk_mul_f32 v[166:167], v[166:167], v[118:119] neg_lo:[1,0] neg_hi:[1,0]
    v_pk_mul_f32 v[168:169], v[168:169], v[120:121] neg_lo:[1,0] neg_hi:[1,0]
    v_pk_mul_f32 v[170:171], v[170:171], v[122:123] neg_lo:[1,0] neg_hi:[1,0]
    v_pk_mul_f32 v[172:173], v[172:173], v[124:125] neg_lo:[1,0] neg_hi:[1,0]
    v_pk_mul_f32 v[174:175], v[174:175], v[126:127] neg_lo:[1,0] neg_hi:[1,0]
    v_pk_mul_f32 v[176:177], v[176:177], v[128:129] neg_lo:[1,0] neg_hi:[1,0]
    v_pk_mul_f32 v[178:179], v[178:179], v[130:131] neg_lo:[1,0] neg_hi:[1,0]
    v_mfma_f32_32x32x16_bf16 v[132:147], a[192:195], a[196:199], 0
    s_waitcnt vmcnt(0) lgkmcnt(0)
    s_barrier
    ds_read_u16 a192, v6 offset:128
    v_exp_f32 v180, v164
    v_exp_f32 v181, v165
    v_mfma_f32_32x32x16_bf16 v[132:147], a[0:3], a[96:99], v[132:147]
    ds_read_b64_tr_b16 a[0:1], v2 offset:12288
    ds_read_b64_tr_b16 a[2:3], v2 offset:12544
    v_exp_f32 v182, v166
    v_exp_f32 v183, v167
    v_mfma_f32_32x32x16_bf16 v[132:147], a[4:7], a[100:103], v[132:147]
L_pad2:
    s_cbranch_execz L_body
    s_nop 0
    s_add_u32 m0, s14, 36480
    s_nop 0
    buffer_load_dwordx4 v255, s[28:31], s16 offen offset:384 lds
    ds_read_b64_tr_b16 a[4:5], v2 offset:14336
    v_exp_f32 v184, v168
    v_exp_f32_e64 v185, v169
    v_mfma_f32_32x32x16_bf16 v[132:147], a[8:11], a[104:107], v[132:147]
    ds_read_b64_tr_b16 a[8:9], v2 offset:16384
    ds_read_b64_tr_b16 a[10:11], v2 offset:16640
    ds_read_b64_tr_b16 a[6:7], v2 offset:14592
    v_exp_f32 v186, v170
    v_exp_f32 v187, v171
    v_mfma_f32_32x32x16_bf16 v[132:147], a[12:15], a[108:111], v[132:147]
    buffer_load_dwordx4 v255, s[28:31], s17 offen offset:1408 lds
    ds_read_b64_tr_b16 a[12:13], v2 offset:18432
    ds_read_b64_tr_b16 a[14:15], v2 offset:18688
    v_exp_f32 v188, v172
    v_exp_f32 v189, v173
    v_mfma_f32_32x32x16_bf16 v[132:147], a[16:19], a[112:115], v[132:147]
    ds_read_b64_tr_b16 a[16:17], v2 offset:20480
    ds_read_b64_tr_b16 a[18:19], v2 offset:20736
    v_exp_f32 v190, v174
    v_exp_f32 v191, v175
    v_mfma_f32_32x32x16_bf16 v[132:147], a[20:23], a[116:119], v[132:147]
    buffer_load_dwordx4 v255, s[28:31], s3 offen offset:2432 lds
    ds_read_b64_tr_b16 a[20:21], v2 offset:22528
    ds_read_b64_tr_b16 a[22:23], v2 offset:22784
    v_exp_f32 v192, v176
    v_exp_f32 v193, v177
    v_exp_f32 v194, v178
    v_exp_f32 v195, v179
    v_pk_add_f32 v[180:181], v[180:181], s[66:67]
    v_pk_add_f32 v[182:183], v[182:183], s[66:67]
    v_pk_add_f32 v[184:185], v[184:185], s[66:67]
    v_pk_add_f32 v[186:187], v[186:187], s[66:67]
    v_pk_add_f32 v[188:189], v[188:189], s[66:67]
    v_pk_add_f32 v[190:191], v[190:191], s[66:67]
    v_pk_add_f32 v[192:193], v[192:193], s[66:67]
    v_pk_add_f32 v[194:195], v[194:195], s[66:67]
    v_pk_fma_f32 v[164:165], v[132:133], v[132:133], s[64:65]
    v_pk_fma_f32 v[166:167], v[134:135], v[134:135], s[64:65]
    v_pk_fma_f32 v[168:169], v[136:137], v[136:137], s[64:65]
    v_pk_fma_f32 v[170:171], v[138:139], v[138:139], s[64:65]
    v_pk_fma_f32 v[172:173], v[140:141], v[140:141], s[64:65]
    v_pk_fma_f32 v[174:175], v[142:143], v[142:143], s[64:65]
    v_pk_fma_f32 v[176:177], v[144:145], v[144:145], s[64:65]
    v_pk_fma_f32 v[178:179], v[146:147], v[146:147], s[64:65]
    v_pk_mul_f32 v[164:165], v[164:165], v[132:133] neg_lo:[1,0] neg_hi:[1,0]
    v_pk_mul_f32 v[166:167], v[166:167], v[134:135] neg_lo:[1,0] neg_hi:[1,0]
    v_pk_mul_f32 v[168:169], v[168:169], v[136:137] neg_lo:[1,0] neg_hi:[1,0]
    v_pk_mul_f32 v[170:171], v[170:171], v[138:139] neg_lo:[1,0] neg_hi:[1,0]
    v_pk_mul_f32 v[172:173], v[172:173], v[140:141] neg_lo:[1,0] neg_hi:[1,0]
    v_pk_mul_f32 v[174:175], v[174:175], v[142:143] neg_lo:[1,0] neg_hi:[1,0]
    v_pk_mul_f32 v[176:177], v[176:177], v[144:145] neg_lo:[1,0] neg_hi:[1,0]
    v_pk_mul_f32 v[178:179], v[178:179], v[146:147] neg_lo:[1,0] neg_hi:[1,0]
    s_waitcnt lgkmcnt(0)
    v_mfma_f32_32x32x16_bf16 v[148:163], a[192:195], a[196:199], 0
    ds_read_b64_tr_b16 a[24:25], v4 offset:0
    ds_read_b64_tr_b16 a[32:33], v4 offset:128
    ds_read_b64_tr_b16 a[44:45], v4 offset:3200
    v_rcp_f32 v196, v180
    v_rcp_f32_e64 v197, v181
    v_mfma_f32_32x32x16_bf16 v[148:163], a[0:3], a[72:75], v[148:163]
    s_add_u32 m0, s14, 48640
    s_nop 0
    buffer_load_dwordx4 v255, s[28:31], s16 offen offset:512 lds
    ds_read_b64_tr_b16 a[46:47], v4 offset:4736
    v_rcp_f32 v198, v182
    v_rcp_f32 v199, v183
    v_rcp_f32 v200, v184
    v_mfma_f32_32x32x16_bf16 v[148:163], a[4:7], a[76:79], v[148:163]
    ds_read_b64_tr_b16 a[26:27], v4 offset:1536
    ds_read_b64_tr_b16 a[34:35], v4 offset:1664
    v_rcp_f32 v201, v185
    v_rcp_f32 v202, v186
    v_rcp_f32_e64 v203, v187
    v_mfma_f32_32x32x16_bf16 v[148:163], a[8:11], a[80:83], v[148:163]
    buffer_load_dwordx4 v255, s[28:31], s17 offen offset:1536 lds
    ds_read_b64_tr_b16 a[36:37], v4 offset:3072
    v_rcp_f32 v204, v188
    v_rcp_f32 v205, v189
    v_rcp_f32_e64 v206, v190
    v_mfma_f32_32x32x16_bf16 v[148:163], a[12:15], a[84:87], v[148:163]
    ds_read_b64_tr_b16 a[28:29], v4 offset:64
    ds_read_b64_tr_b16 a[38:39], v4 offset:4608
    v_rcp_f32 v207, v191
    v_rcp_f32 v208, v192
    v_rcp_f32_e64 v209, v193
    v_mfma_f32_32x32x16_bf16 v[148:163], a[16:19], a[88:91], v[148:163]
    buffer_load_dwordx4 v255, s[28:31], s3 offen offset:2560 lds
    ds_read_b64_tr_b16 a[40:41], v4 offset:3136
    v_rcp_f32 v210, v194
    v_rcp_f32 v211, v195
    v_exp_f32_e64 v180, v164
    v_mfma_f32_32x32x16_bf16 v[148:163], a[20:23], a[92:95], v[148:163]
    ds_read_b64_tr_b16 a[30:31], v4 offset:1600
    ds_read_b64_tr_b16 a[42:43], v4 offset:4672
    v_exp_f32 v181, v165
    v_exp_f32 v182, v166
    v_exp_f32_e64 v183, v167
    v_mfma_f32_32x32x16_bf16 v[68:83], a[216:219], a[196:199], 0
    s_add_u32 m0, s14, 60800
    s_nop 0
    buffer_load_dwordx4 v255, s[28:31], s16 offen offset:640 lds
    v_exp_f32 v184, v168
    v_exp_f32 v185, v169
    v_exp_f32 v186, v170
    v_mfma_f32_32x32x16_bf16 v[84:99], a[218:221], a[196:199], 0
    v_exp_f32 v187, v171
    v_exp_f32 v188, v172
    v_exp_f32_e64 v189, v173
    v_mfma_f32_32x32x16_bf16 v[100:115], a[220:223], a[196:199], 0
    s_waitcnt lgkmcnt(0)
    v_exp_f32 v190, v174
    v_exp_f32 v191, v175
    v_exp_f32 v192, v176
    v_exp_f32 v193, v177
    v_exp_f32 v194, v178
    v_exp_f32_e64 v195, v179
    v_pk_fma_f32 v[164:165], v[148:149], v[148:149], s[64:65]
    v_pk_fma_f32 v[166:167], v[150:151], v[150:151], s[64:65]
    v_pk_fma_f32 v[168:169], v[152:153], v[152:153], s[64:65]
    v_pk_fma_f32 v[170:171], v[154:155], v[154:155], s[64:65]
    v_pk_fma_f32 v[172:173], v[156:157], v[156:157], s[64:65]
    v_pk_fma_f32 v[174:175], v[158:159], v[158:159], s[64:65]
    v_pk_fma_f32 v[176:177], v[160:161], v[160:161], s[64:65]
    v_pk_fma_f32 v[178:179], v[162:163], v[162:163], s[64:65]
    v_pk_mul_f32 v[196:197], v[196:197], v[116:117]
    v_pk_mul_f32 v[198:199], v[198:199], v[118:119]
    v_pk_mul_f32 v[200:201], v[200:201], v[120:121]
    v_pk_mul_f32 v[202:203], v[202:203], v[122:123]
    v_pk_mul_f32 v[204:205], v[204:205], v[124:125]
    v_pk_mul_f32 v[206:207], v[206:207], v[126:127]
    v_pk_mul_f32 v[208:209], v[208:209], v[128:129]
    v_pk_mul_f32 v[210:211], v[210:211], v[130:131]
    v_pk_mul_f32 v[164:165], v[164:165], v[148:149] neg_lo:[1,0] neg_hi:[1,0]
    v_pk_mul_f32 v[166:167], v[166:167], v[150:151] neg_lo:[1,0] neg_hi:[1,0]
    v_pk_mul_f32 v[168:169], v[168:169], v[152:153] neg_lo:[1,0] neg_hi:[1,0]
    v_pk_mul_f32 v[170:171], v[170:171], v[154:155] neg_lo:[1,0] neg_hi:[1,0]
    v_pk_mul_f32 v[172:173], v[172:173], v[156:157] neg_lo:[1,0] neg_hi:[1,0]
    v_pk_mul_f32 v[174:175], v[174:175], v[158:159] neg_lo:[1,0] neg_hi:[1,0]
    v_pk_mul_f32 v[176:177], v[176:177], v[160:161] neg_lo:[1,0] neg_hi:[1,0]
    v_pk_mul_f32 v[178:179], v[178:179], v[162:163] neg_lo:[1,0] neg_hi:[1,0]
    v_pk_add_f32 v[180:181], v[180:181], s[66:67]
    v_pk_add_f32 v[182:183], v[182:183], s[66:67]
    v_pk_add_f32 v[184:185], v[184:185], s[66:67]
    v_pk_add_f32 v[186:187], v[186:187], s[66:67]
    v_pk_add_f32 v[188:189], v[188:189], s[66:67]
    v_pk_add_f32 v[190:191], v[190:191], s[66:67]
    v_pk_add_f32 v[192:193], v[192:193], s[66:67]
    v_pk_add_f32 v[194:195], v[194:195], s[66:67]
    v_mfma_f32_32x32x16_bf16 v[116:131], a[192:195], a[196:199], 0
    ds_read_u16 a192, v6 offset:256
    v_cvt_pk_bf16_f32 v212, v196, v197
    v_cvt_pk_bf16_f32 v213, v198, v199
    v_cvt_pk_bf16_f32 v214, v200, v201
    v_cvt_pk_bf16_f32 v215, v202, v203
    v_cvt_pk_bf16_f32 v216, v204, v205
    v_mfma_f32_32x32x16_bf16 v[116:131], a[0:3], a[96:99], v[116:131]
    buffer_load_dwordx4 v255, s[28:31], s17 offen offset:1664 lds
    ds_read_b64_tr_b16 a[0:1], v2 offset:24576
    v_cvt_pk_bf16_f32 v217, v206, v207
    v_cvt_pk_bf16_f32 v218, v208, v209
    v_cvt_pk_bf16_f32 v219, v210, v211
    v_rcp_f32_e64 v196, v180
    v_mfma_f32_32x32x16_bf16 v[116:131], a[4:7], a[100:103], v[116:131]
    ds_read_b64_tr_b16 a[4:5], v2 offset:26624
    ds_read_b64_tr_b16 a[6:7], v2 offset:26880
    v_rcp_f32 v197, v181
    v_rcp_f32 v198, v182
    v_rcp_f32_e64 v199, v183
    v_mfma_f32_32x32x16_bf16 v[116:131], a[8:11], a[104:107], v[116:131]
    ds_read_b64_tr_b16 a[8:9], v2 offset:28672
    ds_read_b64_tr_b16 a[10:11], v2 offset:28928
    v_rcp_f32 v200, v184
    v_rcp_f32 v201, v185
    v_mfma_f32_32x32x16_bf16 v[116:131], a[12:15], a[108:111], v[116:131]
    buffer_load_dwordx4 v255, s[28:31], s3 offen offset:2688 lds
    ds_read_b64_tr_b16 a[12:13], v2 offset:30720
    v_rcp_f32 v202, v186
    v_rcp_f32 v203, v187
    v_mfma_f32_32x32x16_bf16 v[116:131], a[16:19], a[112:115], v[116:131]
    ds_read_b64_tr_b16 a[16:17], v2 offset:32768
    ds_read_b64_tr_b16 a[14:15], v2 offset:30976
    v_rcp_f32 v204, v188
    v_rcp_f32 v205, v189
    v_rcp_f32_e64 v206, v190
    v_mfma_f32_32x32x16_bf16 v[116:131], a[20:23], a[116:119], v[116:131]
    ds_read_b64_tr_b16 a[20:21], v2 offset:34816
    ds_read_b64_tr_b16 a[2:3], v2 offset:24832
    v_rcp_f32 v207, v191
    v_rcp_f32 v208, v192
    v_mfma_f32_32x32x16_bf16 v[20:35], a[24:27], v[212:215], 0
    s_add_u32 m0, s15, 73728
    s_add_u32 s62, s15, 36864
    buffer_load_dwordx4 v14, s[32:35], s62 offen offset:0 lds
    v_rcp_f32 v209, v193
    v_rcp_f32 v210, v194
    v_mfma_f32_32x32x16_bf16 v[36:51], a[28:31], v[212:215], 0
    ds_read_b64_tr_b16 a[22:23], v2 offset:35072
    v_rcp_f32 v211, v195
    v_exp_f32 v180, v164
    v_exp_f32_e64 v181, v165
    v_mfma_f32_32x32x16_bf16 v[52:67], a[32:35], v[212:215], 0
    ds_read_b64_tr_b16 a[18:19], v2 offset:33024
    v_exp_f32 v182, v166
    v_exp_f32 v183, v167
    v_exp_f32_e64 v184, v168
    v_mfma_f32_32x32x16_bf16 v[20:35], a[36:39], v[216:219], v[20:35]
    buffer_load_dwordx4 v14, s[32:35], s62 offen offset:1024 lds
    v_exp_f32 v185, v169
    v_exp_f32 v186, v170
    v_exp_f32_e64 v187, v171
    v_mfma_f32_32x32x16_bf16 v[36:51], a[40:43], v[216:219], v[36:51]
    v_exp_f32 v188, v172
    v_exp_f32 v189, v173
    v_exp_f32_e64 v190, v174
    v_mfma_f32_32x32x16_bf16 v[52:67], a[44:47], v[216:219], v[52:67]
    s_waitcnt lgkmcnt(0)
    v_exp_f32 v191, v175
    v_exp_f32 v192, v176
    v_exp_f32 v193, v177
    v_exp_f32 v194, v178
    v_exp_f32 v195, v179
    v_pk_fma_f32 v[164:165], v[116:117], v[116:117], s[64:65]
    v_pk_fma_f32 v[166:167], v[118:119], v[118:119], s[64:65]
    v_pk_fma_f32 v[168:169], v[120:121], v[120:121], s[64:65]
    v_pk_fma_f32 v[170:171], v[122:123], v[122:123], s[64:65]
    v_pk_fma_f32 v[172:173], v[124:125], v[124:125], s[64:65]
    v_pk_fma_f32 v[174:175], v[126:127], v[126:127], s[64:65]
    v_pk_fma_f32 v[176:177], v[128:129], v[128:129], s[64:65]
    v_pk_fma_f32 v[178:179], v[130:131], v[130:131], s[64:65]
    v_pk_mul_f32 v[196:197], v[196:197], v[132:133]
    v_pk_mul_f32 v[198:199], v[198:199], v[134:135]
    v_pk_mul_f32 v[200:201], v[200:201], v[136:137]
    v_pk_mul_f32 v[202:203], v[202:203], v[138:139]
    v_pk_mul_f32 v[204:205], v[204:205], v[140:141]
    v_pk_mul_f32 v[206:207], v[206:207], v[142:143]
    v_pk_mul_f32 v[208:209], v[208:209], v[144:145]
    v_pk_mul_f32 v[210:211], v[210:211], v[146:147]
    v_pk_mul_f32 v[164:165], v[164:165], v[116:117] neg_lo:[1,0] neg_hi:[1,0]
    v_pk_mul_f32 v[166:167], v[166:167], v[118:119] neg_lo:[1,0] neg_hi:[1,0]
    v_pk_mul_f32 v[168:169], v[168:169], v[120:121] neg_lo:[1,0] neg_hi:[1,0]
    v_pk_mul_f32 v[170:171], v[170:171], v[122:123] neg_lo:[1,0] neg_hi:[1,0]
    v_pk_mul_f32 v[172:173], v[172:173], v[124:125] neg_lo:[1,0] neg_hi:[1,0]
    v_pk_mul_f32 v[174:175], v[174:175], v[126:127] neg_lo:[1,0] neg_hi:[1,0]
    v_pk_mul_f32 v[176:177], v[176:177], v[128:129] neg_lo:[1,0] neg_hi:[1,0]
    v_pk_mul_f32 v[178:179], v[178:179], v[130:131] neg_lo:[1,0] neg_hi:[1,0]
    v_pk_add_f32 v[180:181], v[180:181], s[66:67]
    v_pk_add_f32 v[182:183], v[182:183], s[66:67]
    v_pk_add_f32 v[184:185], v[184:185], s[66:67]
    v_pk_add_f32 v[186:187], v[186:187], s[66:67]
    v_pk_add_f32 v[188:189], v[188:189], s[66:67]
    v_pk_add_f32 v[190:191], v[190:191], s[66:67]
    v_pk_add_f32 v[192:193], v[192:193], s[66:67]
    v_pk_add_f32 v[194:195], v[194:195], s[66:67]
    v_mfma_f32_32x32x16_bf16 v[132:147], a[192:195], a[196:199], 0
    ds_read_b64_tr_b16 a[48:49], v4 offset:12288
    ds_read_b64_tr_b16 a[62:63], v4 offset:16896
    v_cvt_pk_bf16_f32 v212, v196, v197
    v_cvt_pk_bf16_f32 v213, v198, v199
    v_cvt_pk_bf16_f32 v214, v200, v201
    v_cvt_pk_bf16_f32 v215, v202, v203
    v_mfma_f32_32x32x16_bf16 v[132:147], a[0:3], a[72:75], v[132:147]
    buffer_load_dwordx4 v14, s[32:35], s62 offen offset:2048 lds
    ds_read_b64_tr_b16 a[64:65], v4 offset:15424
    v_cvt_pk_bf16_f32 v216, v204, v205
    v_cvt_pk_bf16_f32 v217, v206, v207
    v_cvt_pk_bf16_f32 v218, v208, v209
    v_cvt_pk_bf16_f32 v219, v210, v211
    v_rcp_f32_e64 v196, v180
    v_mfma_f32_32x32x16_bf16 v[132:147], a[4:7], a[76:79], v[132:147]
    ds_read_b64_tr_b16 a[50:51], v4 offset:13824
    ds_read_b64_tr_b16 a[66:67], v4 offset:16960
    v_rcp_f32 v197, v181
    v_rcp_f32 v198, v182
    v_mfma_f32_32x32x16_bf16 v[132:147], a[8:11], a[80:83], v[132:147]
    ds_read_b64_tr_b16 a[52:53], v4 offset:12352
    ds_read_b64_tr_b16 a[68:69], v4 offset:15488
    v_rcp_f32 v199, v183
    v_rcp_f32 v200, v184
    v_mfma_f32_32x32x16_bf16 v[132:147], a[12:15], a[84:87], v[132:147]
    buffer_load_dwordx4 v14, s[32:35], s62 offen offset:3072 lds
    ds_read_b64_tr_b16 a[70:71], v4 offset:17024
    v_rcp_f32 v201, v185
    v_rcp_f32 v202, v186
    v_mfma_f32_32x32x16_bf16 v[132:147], a[16:19], a[88:91], v[132:147]
    ds_read_b64_tr_b16 a[54:55], v4 offset:13888
    v_rcp_f32 v203, v187
    v_rcp_f32 v204, v188
    v_rcp_f32_e64 v205, v189
    v_mfma_f32_32x32x16_bf16 v[132:147], a[20:23], a[92:95], v[132:147]
    ds_read_b64_tr_b16 a[56:57], v4 offset:12416
    v_rcp_f32 v206, v190
    v_rcp_f32 v207, v191
    v_rcp_f32_e64 v208, v192
    v_mfma_f32_32x32x16_bf16 v[68:83], a[24:27], v[212:215], v[68:83]
    s_add_u32 m0, s15, 77824
    s_add_u32 s62, s15, 40960
    buffer_load_dwordx4 v14, s[32:35], s62 offen offset:0 lds
    v_rcp_f32 v209, v193
    v_rcp_f32 v210, v194
    v_mfma_f32_32x32x16_bf16 v[84:99], a[28:31], v[212:215], v[84:99]
    ds_read_b64_tr_b16 a[58:59], v4 offset:13952
    v_rcp_f32 v211, v195
    v_exp_f32 v180, v164
    v_exp_f32_e64 v181, v165
    v_mfma_f32_32x32x16_bf16 v[100:115], a[32:35], v[212:215], v[100:115]
    ds_read_b64_tr_b16 a[60:61], v4 offset:15360
    v_exp_f32 v182, v166
    v_exp_f32 v183, v167
    v_exp_f32_e64 v184, v168
    v_mfma_f32_32x32x16_bf16 v[68:83], a[36:39], v[216:219], v[68:83]
    buffer_load_dwordx4 v14, s[32:35], s62 offen offset:1024 lds
    v_exp_f32 v185, v169
    v_exp_f32 v186, v170
    v_exp_f32_e64 v187, v171
    v_mfma_f32_32x32x16_bf16 v[84:99], a[40:43], v[216:219], v[84:99]
    v_exp_f32 v188, v172
    v_exp_f32 v189, v173
    v_exp_f32_e64 v190, v174
    v_mfma_f32_32x32x16_bf16 v[100:115], a[44:47], v[216:219], v[100:115]
    s_waitcnt lgkmcnt(0)
    v_exp_f32 v191, v175
    v_exp_f32 v192, v176
    v_exp_f32 v193, v177
    v_exp_f32 v194, v178
    v_exp_f32 v195, v179
    v_pk_fma_f32 v[164:165], v[132:133], v[132:133], s[64:65]
    v_pk_fma_f32 v[166:167], v[134:135], v[134:135], s[64:65]
    v_pk_fma_f32 v[168:169], v[136:137], v[136:137], s[64:65]
    v_pk_fma_f32 v[170:171], v[138:139], v[138:139], s[64:65]
    v_pk_fma_f32 v[172:173], v[140:141], v[140:141], s[64:65]
    v_pk_fma_f32 v[174:175], v[142:143], v[142:143], s[64:65]
    v_pk_fma_f32 v[176:177], v[144:145], v[144:145], s[64:65]
    v_pk_fma_f32 v[178:179], v[146:147], v[146:147], s[64:65]
    v_pk_mul_f32 v[196:197], v[196:197], v[148:149]
    v_pk_mul_f32 v[198:199], v[198:199], v[150:151]
    v_pk_mul_f32 v[200:201], v[200:201], v[152:153]
    v_pk_mul_f32 v[202:203], v[202:203], v[154:155]
    v_pk_mul_f32 v[204:205], v[204:205], v[156:157]
    v_pk_mul_f32 v[206:207], v[206:207], v[158:159]
    v_pk_mul_f32 v[208:209], v[208:209], v[160:161]
    v_pk_mul_f32 v[210:211], v[210:211], v[162:163]
    v_pk_mul_f32 v[164:165], v[164:165], v[132:133] neg_lo:[1,0] neg_hi:[1,0]
    v_pk_mul_f32 v[166:167], v[166:167], v[134:135] neg_lo:[1,0] neg_hi:[1,0]
    v_pk_mul_f32 v[168:169], v[168:169], v[136:137] neg_lo:[1,0] neg_hi:[1,0]
    v_pk_mul_f32 v[170:171], v[170:171], v[138:139] neg_lo:[1,0] neg_hi:[1,0]
    v_pk_mul_f32 v[172:173], v[172:173], v[140:141] neg_lo:[1,0] neg_hi:[1,0]
    v_pk_mul_f32 v[174:175], v[174:175], v[142:143] neg_lo:[1,0] neg_hi:[1,0]
    v_pk_mul_f32 v[176:177], v[176:177], v[144:145] neg_lo:[1,0] neg_hi:[1,0]
    v_pk_mul_f32 v[178:179], v[178:179], v[146:147] neg_lo:[1,0] neg_hi:[1,0]
    v_pk_add_f32 v[180:181], v[180:181], s[66:67]
    v_pk_add_f32 v[182:183], v[182:183], s[66:67]
    v_pk_add_f32 v[184:185], v[184:185], s[66:67]
    v_pk_add_f32 v[186:187], v[186:187], s[66:67]
    v_pk_add_f32 v[188:189], v[188:189], s[66:67]
    v_pk_add_f32 v[190:191], v[190:191], s[66:67]
    v_pk_add_f32 v[192:193], v[192:193], s[66:67]
    v_pk_add_f32 v[194:195], v[194:195], s[66:67]
    v_mfma_f32_32x32x16_bf16 v[148:163], a[192:195], a[196:199], 0
    buffer_load_dwordx4 v14, s[32:35], s62 offen offset:2048 lds
    ds_read_u16 a192, v7 offset:0
    v_cvt_pk_bf16_f32 v212, v196, v197
    v_cvt_pk_bf16_f32 v213, v198, v199
    v_cvt_pk_bf16_f32 v214, v200, v201
    v_cvt_pk_bf16_f32 v215, v202, v203
    v_mfma_f32_32x32x16_bf16 v[148:163], a[0:3], a[96:99], v[148:163]
    ds_read_b64_tr_b16 a[0:1], v3 offset:0
    ds_read_b64_tr_b16 a[2:3], v3 offset:256
    v_cvt_pk_bf16_f32 v216, v204, v205
    v_cvt_pk_bf16_f32 v217, v206, v207
    v_cvt_pk_bf16_f32 v218, v208, v209
    v_cvt_pk_bf16_f32 v219, v210, v211
    v_rcp_f32_e64 v196, v180
    v_mfma_f32_32x32x16_bf16 v[148:163], a[4:7], a[100:103], v[148:163]
    ds_read_b64_tr_b16 a[4:5], v3 offset:2048
    ds_read_b64_tr_b16 a[6:7], v3 offset:2304
    v_rcp_f32 v197, v181
    v_rcp_f32 v198, v182
    v_mfma_f32_32x32x16_bf16 v[148:163], a[8:11], a[104:107], v[148:163]
    ds_read_b64_tr_b16 a[8:9], v3 offset:4096
    ds_read_b64_tr_b16 a[10:11], v3 offset:4352
    v_rcp_f32 v199, v183
    v_rcp_f32 v200, v184
    v_mfma_f32_32x32x16_bf16 v[148:163], a[12:15], a[108:111], v[148:163]
    buffer_load_dwordx4 v14, s[32:35], s62 offen offset:3072 lds
    ds_read_b64_tr_b16 a[12:13], v3 offset:6144
    v_rcp_f32 v201, v185
    v_rcp_f32 v202, v186
    v_mfma_f32_32x32x16_bf16 v[148:163], a[16:19], a[112:115], v[148:163]
    ds_read_b64_tr_b16 a[16:17], v3 offset:8192
    ds_read_b64_tr_b16 a[14:15], v3 offset:6400
    v_rcp_f32 v203, v187
    v_rcp_f32 v204, v188
    v_rcp_f32_e64 v205, v189
    v_mfma_f32_32x32x16_bf16 v[148:163], a[20:23], a[116:119], v[148:163]
    ds_read_b64_tr_b16 a[20:21], v3 offset:10240
    v_rcp_f32 v206, v190
    v_rcp_f32 v207, v191
    v_rcp_f32_e64 v208, v192
    v_mfma_f32_32x32x16_bf16 v[20:35], a[48:51], v[212:215], v[20:35]
    ds_read_b64_tr_b16 a[22:23], v3 offset:10496
    v_rcp_f32 v209, v193
    v_rcp_f32 v210, v194
    v_mfma_f32_32x32x16_bf16 v[36:51], a[52:55], v[212:215], v[36:51]
    s_add_u32 m0, s15, 81920
    s_add_u32 s62, s15, 45056
    buffer_load_dwordx4 v14, s[32:35], s62 offen offset:0 lds
    v_rcp_f32 v211, v195
    v_exp_f32 v180, v164
    v_exp_f32_e64 v181, v165
    v_mfma_f32_32x32x16_bf16 v[52:67], a[56:59], v[212:215], v[52:67]
    ds_read_b64_tr_b16 a[18:19], v3 offset:8448
    v_exp_f32 v182, v166
    v_exp_f32 v183, v167
    v_mfma_f32_32x32x16_bf16 v[20:35], a[60:63], v[216:219], v[20:35]
    v_exp_f32 v184, v168
    v_exp_f32 v185, v169
    v_exp_f32 v186, v170
    v_exp_f32 v187, v171
    v_mfma_f32_32x32x16_bf16 v[36:51], a[64:67], v[216:219], v[36:51]
    v_exp_f32 v188, v172
    v_exp_f32 v189, v173
    v_exp_f32_e64 v190, v174
    v_mfma_f32_32x32x16_bf16 v[52:67], a[68:71], v[216:219], v[52:67]
    s_waitcnt lgkmcnt(0)
    v_exp_f32 v191, v175
    v_exp_f32 v192, v176
    v_exp_f32 v193, v177
    v_exp_f32 v194, v178
    v_exp_f32 v195, v179
    v_pk_fma_f32 v[164:165], v[148:149], v[148:149], s[64:65]
    v_pk_fma_f32 v[166:167], v[150:151], v[150:151], s[64:65]
    v_pk_fma_f32 v[168:169], v[152:153], v[152:153], s[64:65]
    v_pk_fma_f32 v[170:171], v[154:155], v[154:155], s[64:65]
    v_pk_fma_f32 v[172:173], v[156:157], v[156:157], s[64:65]
    v_pk_fma_f32 v[174:175], v[158:159], v[158:159], s[64:65]
    v_pk_fma_f32 v[176:177], v[160:161], v[160:161], s[64:65]
    v_pk_fma_f32 v[178:179], v[162:163], v[162:163], s[64:65]
    v_pk_mul_f32 v[196:197], v[196:197], v[116:117]
    v_pk_mul_f32 v[198:199], v[198:199], v[118:119]
    v_pk_mul_f32 v[200:201], v[200:201], v[120:121]
    v_pk_mul_f32 v[202:203], v[202:203], v[122:123]
    v_pk_mul_f32 v[204:205], v[204:205], v[124:125]
    v_pk_mul_f32 v[206:207], v[206:207], v[126:127]
    v_pk_mul_f32 v[208:209], v[208:209], v[128:129]
    v_pk_mul_f32 v[210:211], v[210:211], v[130:131]
    v_pk_mul_f32 v[164:165], v[164:165], v[148:149] neg_lo:[1,0] neg_hi:[1,0]
    v_pk_mul_f32 v[166:167], v[166:167], v[150:151] neg_lo:[1,0] neg_hi:[1,0]
    v_pk_mul_f32 v[168:169], v[168:169], v[152:153] neg_lo:[1,0] neg_hi:[1,0]
    v_pk_mul_f32 v[170:171], v[170:171], v[154:155] neg_lo:[1,0] neg_hi:[1,0]
    v_pk_mul_f32 v[172:173], v[172:173], v[156:157] neg_lo:[1,0] neg_hi:[1,0]
    v_pk_mul_f32 v[174:175], v[174:175], v[158:159] neg_lo:[1,0] neg_hi:[1,0]
    v_pk_mul_f32 v[176:177], v[176:177], v[160:161] neg_lo:[1,0] neg_hi:[1,0]
    v_pk_mul_f32 v[178:179], v[178:179], v[162:163] neg_lo:[1,0] neg_hi:[1,0]
    v_pk_add_f32 v[180:181], v[180:181], s[66:67]
    v_pk_add_f32 v[182:183], v[182:183], s[66:67]
    v_pk_add_f32 v[184:185], v[184:185], s[66:67]
    v_pk_add_f32 v[186:187], v[186:187], s[66:67]
    v_pk_add_f32 v[188:189], v[188:189], s[66:67]
    v_pk_add_f32 v[190:191], v[190:191], s[66:67]
    v_pk_add_f32 v[192:193], v[192:193], s[66:67]
    v_pk_add_f32 v[194:195], v[194:195], s[66:67]
    v_mfma_f32_32x32x16_bf16 v[116:131], a[192:195], a[196:199], 0
    ds_read_u16 a192, v7 offset:128
    ds_read_b64_tr_b16 a[24:25], v4 offset:24576
    ds_read_b64_tr_b16 a[38:39], v4 offset:29184
    v_cvt_pk_bf16_f32 v212, v196, v197
    v_cvt_pk_bf16_f32 v213, v198, v199
    v_cvt_pk_bf16_f32 v214, v200, v201
    v_cvt_pk_bf16_f32 v215, v202, v203
    v_mfma_f32_32x32x16_bf16 v[116:131], a[0:3], a[72:75], v[116:131]
    ds_read_b64_tr_b16 a[0:1], v3 offset:12288
    ds_read_b64_tr_b16 a[2:3], v3 offset:12544
    ds_read_b64_tr_b16 a[40:41], v4 offset:27712
    v_cvt_pk_bf16_f32 v216, v204, v205
    v_cvt_pk_bf16_f32 v217, v206, v207
    v_cvt_pk_bf16_f32 v218, v208, v209
    v_cvt_pk_bf16_f32 v219, v210, v211
    v_mfma_f32_32x32x16_bf16 v[116:131], a[4:7], a[76:79], v[116:131]
    ds_read_b64_tr_b16 a[4:5], v3 offset:14336
    ds_read_b64_tr_b16 a[6:7], v3 offset:14592
    ds_read_b64_tr_b16 a[42:43], v4 offset:29248
    v_rcp_f32 v196, v180
    v_rcp_f32 v197, v181
    v_mfma_f32_32x32x16_bf16 v[116:131], a[8:11], a[80:83], v[116:131]
    ds_read_b64_tr_b16 a[8:9], v3 offset:16384
    ds_read_b64_tr_b16 a[10:11], v3 offset:16640
    ds_read_b64_tr_b16 a[44:45], v4 offset:27776
    v_rcp_f32 v198, v182
    v_rcp_f32 v199, v183
    v_mfma_f32_32x32x16_bf16 v[116:131], a[12:15], a[84:87], v[116:131]
    ds_read_b64_tr_b16 a[12:13], v3 offset:18432
    ds_read_b64_tr_b16 a[26:27], v4 offset:26112
    ds_read_b64_tr_b16 a[46:47], v4 offset:29312
    v_rcp_f32 v200, v184
    v_rcp_f32 v201, v185
    v_rcp_f32_e64 v202, v186
    v_mfma_f32_32x32x16_bf16 v[116:131], a[16:19], a[88:91], v[116:131]
    ds_read_b64_tr_b16 a[16:17], v3 offset:20480
    ds_read_b64_tr_b16 a[28:29], v4 offset:24640
    v_rcp_f32 v203, v187
    v_rcp_f32 v204, v188
    v_mfma_f32_32x32x16_bf16 v[116:131], a[20:23], a[92:95], v[116:131]
    ds_read_b64_tr_b16 a[20:21], v3 offset:22528
    ds_read_b64_tr_b16 a[30:31], v4 offset:26176
    v_rcp_f32 v205, v189
    v_rcp_f32 v206, v190
    v_rcp_f32_e64 v207, v191
    v_mfma_f32_32x32x16_bf16 v[68:83], a[48:51], v[212:215], v[68:83]
    ds_read_b64_tr_b16 a[22:23], v3 offset:22784
    ds_read_b64_tr_b16 a[32:33], v4 offset:24704
    v_rcp_f32 v208, v192
    v_rcp_f32 v209, v193
    v_mfma_f32_32x32x16_bf16 v[84:99], a[52:55], v[212:215], v[84:99]
    ds_read_b64_tr_b16 a[18:19], v3 offset:20736
    ds_read_b64_tr_b16 a[34:35], v4 offset:26240
    v_rcp_f32 v210, v194
    v_rcp_f32 v211, v195
    v_exp_f32_e64 v180, v164
    v_mfma_f32_32x32x16_bf16 v[100:115], a[56:59], v[212:215], v[100:115]
    ds_read_b64_tr_b16 a[14:15], v3 offset:18688
    ds_read_b64_tr_b16 a[36:37], v4 offset:27648
    v_exp_f32 v181, v165
    v_exp_f32 v182, v166
    v_exp_f32_e64 v183, v167
    v_mfma_f32_32x32x16_bf16 v[68:83], a[60:63], v[216:219], v[68:83]
    v_exp_f32 v184, v168
    v_exp_f32 v185, v169
    v_exp_f32_e64 v186, v170
    v_mfma_f32_32x32x16_bf16 v[84:99], a[64:67], v[216:219], v[84:99]
    v_exp_f32 v187, v171
    v_exp_f32 v188, v172
    v_exp_f32 v189, v173
    v_exp_f32 v190, v174
    v_mfma_f32_32x32x16_bf16 v[100:115], a[68:71], v[216:219], v[100:115]
    s_waitcnt lgkmcnt(0)
    v_exp_f32 v191, v175
    v_exp_f32 v192, v176
    v_exp_f32 v193, v177
    v_exp_f32 v194, v178
    v_exp_f32 v195, v179
    v_pk_fma_f32 v[164:165], v[116:117], v[116:117], s[64:65]
    v_pk_fma_f32 v[166:167], v[118:119], v[118:119], s[64:65]
    v_pk_fma_f32 v[168:169], v[120:121], v[120:121], s[64:65]
    v_pk_fma_f32 v[170:171], v[122:123], v[122:123], s[64:65]
    v_pk_fma_f32 v[172:173], v[124:125], v[124:125], s[64:65]
    v_pk_fma_f32 v[174:175], v[126:127], v[126:127], s[64:65]
    v_pk_fma_f32 v[176:177], v[128:129], v[128:129], s[64:65]
    v_pk_fma_f32 v[178:179], v[130:131], v[130:131], s[64:65]
    v_pk_mul_f32 v[196:197], v[196:197], v[132:133]
    v_pk_mul_f32 v[198:199], v[198:199], v[134:135]
    v_pk_mul_f32 v[200:201], v[200:201], v[136:137]
    v_pk_mul_f32 v[202:203], v[202:203], v[138:139]
    v_pk_mul_f32 v[204:205], v[204:205], v[140:141]
    v_pk_mul_f32 v[206:207], v[206:207], v[142:143]
    v_pk_mul_f32 v[208:209], v[208:209], v[144:145]
    v_pk_mul_f32 v[210:211], v[210:211], v[146:147]
    v_pk_mul_f32 v[164:165], v[164:165], v[116:117] neg_lo:[1,0] neg_hi:[1,0]
    v_pk_mul_f32 v[166:167], v[166:167], v[118:119] neg_lo:[1,0] neg_hi:[1,0]
    v_pk_mul_f32 v[168:169], v[168:169], v[120:121] neg_lo:[1,0] neg_hi:[1,0]
    v_pk_mul_f32 v[170:171], v[170:171], v[122:123] neg_lo:[1,0] neg_hi:[1,0]
    v_pk_mul_f32 v[172:173], v[172:173], v[124:125] neg_lo:[1,0] neg_hi:[1,0]
    v_pk_mul_f32 v[174:175], v[174:175], v[126:127] neg_lo:[1,0] neg_hi:[1,0]
    v_pk_mul_f32 v[176:177], v[176:177], v[128:129] neg_lo:[1,0] neg_hi:[1,0]
    v_pk_mul_f32 v[178:179], v[178:179], v[130:131] neg_lo:[1,0] neg_hi:[1,0]
    v_pk_add_f32 v[180:181], v[180:181], s[66:67]
    v_pk_add_f32 v[182:183], v[182:183], s[66:67]
    v_pk_add_f32 v[184:185], v[184:185], s[66:67]
    v_pk_add_f32 v[186:187], v[186:187], s[66:67]
    v_pk_add_f32 v[188:189], v[188:189], s[66:67]
    v_pk_add_f32 v[190:191], v[190:191], s[66:67]
    v_pk_add_f32 v[192:193], v[192:193], s[66:67]
    v_pk_add_f32 v[194:195], v[194:195], s[66:67]
    v_mfma_f32_32x32x16_bf16 v[132:147], a[192:195], a[196:199], 0
    ds_read_u16 a216, v17 offset:0
    ds_read_b64_tr_b16 a[186:187], v18 offset:4352
    ds_read_u16 a192, v7 offset:256
    v_cvt_pk_bf16_f32 v212, v196, v197
    v_cvt_pk_bf16_f32 v213, v198, v199
    v_cvt_pk_bf16_f32 v214, v200, v201
    v_mfma_f32_32x32x16_bf16 v[132:147], a[0:3], a[72:75], v[132:147]
    ds_read_u16 a218, v17 offset:32
    ds_read_b64_tr_b16 a[176:177], v16 offset:8192
L_pad3:
    s_cbranch_execz L_pad4
    s_nop 0
    ds_read_b64_tr_b16 a[0:1], v3 offset:24576
    v_cvt_pk_bf16_f32 v215, v202, v203
    v_cvt_pk_bf16_f32 v216, v204, v205
    v_cvt_pk_bf16_f32 v217, v206, v207
    v_mfma_f32_32x32x16_bf16 v[132:147], a[4:7], a[76:79], v[132:147]
    ds_read_b64_tr_b16 a[168:169], v16 offset:0
    ds_read_b64_tr_b16 a[178:179], v16 offset:8448
    ds_read_b64_tr_b16 a[4:5], v3 offset:26624
    v_cvt_pk_bf16_f32 v218, v208, v209
    v_cvt_pk_bf16_f32 v219, v210, v211
    v_rcp_f32_e64 v196, v180
    v_mfma_f32_32x32x16_bf16 v[132:147], a[8:11], a[80:83], v[132:147]
    ds_read_b64_tr_b16 a[170:171], v16 offset:256
    ds_read_b64_tr_b16 a[188:189], v18 offset:8192
    ds_read_b64_tr_b16 a[8:9], v3 offset:28672
    v_rcp_f32_e64 v197, v181
    v_mfma_f32_32x32x16_bf16 v[132:147], a[12:15], a[84:87], v[132:147]
    ds_read_b64_tr_b16 a[180:181], v18 offset:0
    ds_read_b64_tr_b16 a[190:191], v18 offset:8448
    ds_read_b64_tr_b16 a[10:11], v3 offset:28928
    v_rcp_f32 v198, v182
    v_rcp_f32 v199, v183
    v_mfma_f32_32x32x16_bf16 v[132:147], a[16:19], a[88:91], v[132:147]
    ds_read_b64_tr_b16 a[182:183], v18 offset:256
    ds_read_b64_tr_b16 a[16:17], v3 offset:32768
    ds_read_b64_tr_b16 a[6:7], v3 offset:26880
    v_rcp_f32_e64 v200, v184
    v_mfma_f32_32x32x16_bf16 v[132:147], a[20:23], a[92:95], v[132:147]
    ds_read_b64_tr_b16 a[172:173], v16 offset:4096
    ds_read_b64_tr_b16 a[22:23], v3 offset:35072
    ds_read_b64_tr_b16 a[2:3], v3 offset:24832
    v_rcp_f32 v201, v185
    v_rcp_f32 v202, v186
    v_mfma_f32_32x32x16_bf16 v[20:35], a[24:27], v[212:215], v[20:35]
    ds_read_b64_tr_b16 a[174:175], v16 offset:4352
    ds_read_b64_tr_b16 a[18:19], v3 offset:33024
    v_rcp_f32 v203, v187
    v_rcp_f32 v204, v188
    v_mfma_f32_32x32x16_bf16 v[36:51], a[28:31], v[212:215], v[36:51]
    ds_read_b64_tr_b16 a[184:185], v18 offset:4096
    ds_read_b64_tr_b16 a[12:13], v3 offset:30720
    v_rcp_f32 v205, v189
    v_rcp_f32 v206, v190
    v_mfma_f32_32x32x16_bf16 v[52:67], a[32:35], v[212:215], v[52:67]
    ds_read_b64_tr_b16 a[20:21], v3 offset:34816
    ds_read_b64_tr_b16 a[14:15], v3 offset:30976
    v_rcp_f32 v207, v191
    v_rcp_f32 v208, v192
    v_mfma_f32_32x32x16_bf16 v[20:35], a[36:39], v[216:219], v[20:35]
    v_rcp_f32 v209, v193
    v_rcp_f32 v210, v194
    v_rcp_f32_e64 v211, v195
    v_mfma_f32_32x32x16_bf16 v[36:51], a[40:43], v[216:219], v[36:51]
    v_exp_f32 v180, v164
    v_exp_f32 v181, v165
    v_exp_f32_e64 v182, v166
    v_mfma_f32_32x32x16_bf16 v[52:67], a[44:47], v[216:219], v[52:67]
    s_waitcnt lgkmcnt(3)
    v_exp_f32 v183, v167
    v_exp_f32 v184, v168
    v_exp_f32 v185, v169
    v_mfma_f32_16x16x32_bf16 v[224:227], a[216:219], a[200:203], 0
    v_exp_f32_e64 v186, v170
    v_mfma_f32_16x16x32_bf16 v[224:227], a[168:171], a[120:123], v[224:227]
    v_exp_f32_e64 v187, v171
    v_mfma_f32_16x16x32_bf16 v[224:227], a[172:175], a[124:127], v[224:227]
    v_exp_f32_e64 v188, v172
    v_mfma_f32_16x16x32_bf16 v[224:227], a[176:179], a[128:131], v[224:227]
    v_exp_f32_e64 v189, v173
    v_mfma_f32_16x16x32_bf16 v[224:227], a[218:221], a[204:207], v[224:227]
    v_exp_f32_e64 v190, v174
    v_mfma_f32_16x16x32_bf16 v[224:227], a[180:183], a[132:135], v[224:227]
    v_exp_f32_e64 v191, v175
    v_mfma_f32_16x16x32_bf16 v[224:227], a[184:187], a[136:139], v[224:227]
    v_exp_f32_e64 v192, v176
    v_mfma_f32_16x16x32_bf16 v[224:227], a[188:191], a[140:143], v[224:227]
    s_waitcnt lgkmcnt(0)
    v_exp_f32 v193, v177
    v_exp_f32 v194, v178
    v_exp_f32 v195, v179
    v_subrev_u32 v4, 36864, v4
    v_add_u32 v2, 36864, v2
    v_pk_fma_f32 v[164:165], v[132:133], v[132:133], s[64:65]
    v_pk_fma_f32 v[166:167], v[134:135], v[134:135], s[64:65]
    v_pk_fma_f32 v[168:169], v[136:137], v[136:137], s[64:65]
    v_pk_fma_f32 v[170:171], v[138:139], v[138:139], s[64:65]
    v_pk_fma_f32 v[172:173], v[140:141], v[140:141], s[64:65]
    v_pk_fma_f32 v[174:175], v[142:143], v[142:143], s[64:65]
    v_pk_fma_f32 v[176:177], v[144:145], v[144:145], s[64:65]
    v_pk_fma_f32 v[178:179], v[146:147], v[146:147], s[64:65]
    v_pk_mul_f32 v[196:197], v[196:197], v[148:149]
    v_pk_mul_f32 v[198:199], v[198:199], v[150:151]
    v_pk_mul_f32 v[200:201], v[200:201], v[152:153]
    v_pk_mul_f32 v[202:203], v[202:203], v[154:155]
    v_pk_mul_f32 v[204:205], v[204:205], v[156:157]
    v_pk_mul_f32 v[206:207], v[206:207], v[158:159]
    v_pk_mul_f32 v[208:209], v[208:209], v[160:161]
    v_pk_mul_f32 v[210:211], v[210:211], v[162:163]
    v_pk_mul_f32 v[164:165], v[164:165], v[132:133] neg_lo:[1,0] neg_hi:[1,0]
    v_pk_mul_f32 v[166:167], v[166:167], v[134:135] neg_lo:[1,0] neg_hi:[1,0]
    v_pk_mul_f32 v[168:169], v[168:169], v[136:137] neg_lo:[1,0] neg_hi:[1,0]
    v_pk_mul_f32 v[170:171], v[170:171], v[138:139] neg_lo:[1,0] neg_hi:[1,0]
    v_pk_mul_f32 v[172:173], v[172:173], v[140:141] neg_lo:[1,0] neg_hi:[1,0]
    v_pk_mul_f32 v[174:175], v[174:175], v[142:143] neg_lo:[1,0] neg_hi:[1,0]
    v_pk_mul_f32 v[176:177], v[176:177], v[144:145] neg_lo:[1,0] neg_hi:[1,0]
    v_pk_mul_f32 v[178:179], v[178:179], v[146:147] neg_lo:[1,0] neg_hi:[1,0]
    v_pk_add_f32 v[180:181], v[180:181], s[66:67]
    v_pk_add_f32 v[182:183], v[182:183], s[66:67]
    v_pk_add_f32 v[184:185], v[184:185], s[66:67]
    v_pk_add_f32 v[186:187], v[186:187], s[66:67]
    v_pk_add_f32 v[188:189], v[188:189], s[66:67]
    v_pk_add_f32 v[190:191], v[190:191], s[66:67]
    v_pk_add_f32 v[192:193], v[192:193], s[66:67]
    v_pk_add_f32 v[194:195], v[194:195], s[66:67]
    s_waitcnt vmcnt(0)
    s_barrier
    v_mfma_f32_32x32x16_bf16 v[148:163], a[192:195], a[196:199], 0
    ds_read_u16 a192, v6 offset:384
    ds_read_b64_tr_b16 a[48:49], v5 offset:0
    ds_read_b64_tr_b16 a[62:63], v5 offset:4608
    v_cvt_pk_bf16_f32 v212, v196, v197
    v_cvt_pk_bf16_f32 v213, v198, v199
    v_cvt_pk_bf16_f32 v214, v200, v201
    v_cvt_pk_bf16_f32 v215, v202, v203
    v_mfma_f32_32x32x16_bf16 v[148:163], a[0:3], a[72:75], v[148:163]
    ds_read_b64_tr_b16 a[0:1], v2 offset:0
    ds_read_b64_tr_b16 a[2:3], v2 offset:256
    ds_read_b64_tr_b16 a[64:65], v5 offset:3136
    v_cvt_pk_bf16_f32 v216, v204, v205
    v_cvt_pk_bf16_f32 v217, v206, v207
    v_cvt_pk_bf16_f32 v218, v208, v209
    v_cvt_pk_bf16_f32 v219, v210, v211
    v_mfma_f32_32x32x16_bf16 v[148:163], a[4:7], a[76:79], v[148:163]
    ds_read_b64_tr_b16 a[4:5], v2 offset:2048
    ds_read_b64_tr_b16 a[6:7], v2 offset:2304
    ds_read_b64_tr_b16 a[66:67], v5 offset:4672
    v_rcp_f32 v196, v180
    v_rcp_f32 v197, v181
    v_mfma_f32_32x32x16_bf16 v[148:163], a[8:11], a[80:83], v[148:163]
    ds_read_b64_tr_b16 a[8:9], v2 offset:4096
    ds_read_b64_tr_b16 a[10:11], v2 offset:4352
    ds_read_b64_tr_b16 a[68:69], v5 offset:3200
    v_rcp_f32 v198, v182
    v_rcp_f32 v199, v183
    v_mfma_f32_32x32x16_bf16 v[148:163], a[12:15], a[84:87], v[148:163]
    ds_read_b64_tr_b16 a[12:13], v2 offset:6144
    ds_read_b64_tr_b16 a[50:51], v5 offset:1536
    ds_read_b64_tr_b16 a[70:71], v5 offset:4736
    v_rcp_f32 v200, v184
    v_rcp_f32 v201, v185
    v_rcp_f32_e64 v202, v186
    v_mfma_f32_32x32x16_bf16 v[148:163], a[16:19], a[88:91], v[148:163]
    ds_read_b64_tr_b16 a[16:17], v2 offset:8192
    ds_read_b64_tr_b16 a[52:53], v5 offset:64
    v_rcp_f32 v203, v187
    v_rcp_f32 v204, v188
    v_mfma_f32_32x32x16_bf16 v[148:163], a[20:23], a[92:95], v[148:163]
    ds_read_b64_tr_b16 a[20:21], v2 offset:10240
    ds_read_b64_tr_b16 a[54:55], v5 offset:1600
    v_rcp_f32 v205, v189
    v_rcp_f32 v206, v190
    v_rcp_f32_e64 v207, v191
    v_mfma_f32_32x32x16_bf16 v[68:83], a[24:27], v[212:215], v[68:83]
    ds_read_b64_tr_b16 a[22:23], v2 offset:10496
    ds_read_b64_tr_b16 a[56:57], v5 offset:128
    v_rcp_f32 v208, v192
    v_rcp_f32 v209, v193
    v_mfma_f32_32x32x16_bf16 v[84:99], a[28:31], v[212:215], v[84:99]
    ds_read_b64_tr_b16 a[18:19], v2 offset:8448
    ds_read_b64_tr_b16 a[58:59], v5 offset:1664
    v_rcp_f32 v210, v194
    v_rcp_f32 v211, v195
    v_exp_f32_e64 v180, v164
    v_mfma_f32_32x32x16_bf16 v[100:115], a[32:35], v[212:215], v[100:115]
    ds_read_b64_tr_b16 a[14:15], v2 offset:6400
    ds_read_b64_tr_b16 a[60:61], v5 offset:3072
    v_exp_f32 v181, v165
    v_exp_f32 v182, v166
    v_exp_f32_e64 v183, v167
    v_mfma_f32_32x32x16_bf16 v[68:83], a[36:39], v[216:219], v[68:83]
    v_exp_f32 v184, v168
    v_exp_f32 v185, v169
    v_exp_f32_e64 v186, v170
    v_mfma_f32_32x32x16_bf16 v[84:99], a[40:43], v[216:219], v[84:99]
    v_exp_f32 v187, v171
    v_exp_f32 v188, v172
    v_exp_f32 v189, v173
    v_exp_f32 v190, v174
    v_mfma_f32_32x32x16_bf16 v[100:115], a[44:47], v[216:219], v[100:115]
    s_waitcnt lgkmcnt(0)
    v_exp_f32 v191, v175
    v_exp_f32 v192, v176
    v_exp_f32 v193, v177
    v_exp_f32 v194, v178
    v_exp_f32 v195, v179
    v_pk_fma_f32 v[164:165], v[148:149], v[148:149], s[64:65]
    v_pk_fma_f32 v[166:167], v[150:151], v[150:151], s[64:65]
    v_pk_fma_f32 v[168:169], v[152:153], v[152:153], s[64:65]
    v_pk_fma_f32 v[170:171], v[154:155], v[154:155], s[64:65]
    v_pk_fma_f32 v[172:173], v[156:157], v[156:157], s[64:65]
    v_pk_fma_f32 v[174:175], v[158:159], v[158:159], s[64:65]
    v_pk_fma_f32 v[176:177], v[160:161], v[160:161], s[64:65]
    v_pk_fma_f32 v[178:179], v[162:163], v[162:163], s[64:65]
    v_pk_mul_f32 v[196:197], v[196:197], v[116:117]
    v_pk_mul_f32 v[198:199], v[198:199], v[118:119]
    v_pk_mul_f32 v[200:201], v[200:201], v[120:121]
    v_pk_mul_f32 v[202:203], v[202:203], v[122:123]
    v_pk_mul_f32 v[204:205], v[204:205], v[124:125]
    v_pk_mul_f32 v[206:207], v[206:207], v[126:127]
    v_pk_mul_f32 v[208:209], v[208:209], v[128:129]
    v_pk_mul_f32 v[210:211], v[210:211], v[130:131]
    v_pk_mul_f32 v[164:165], v[164:165], v[148:149] neg_lo:[1,0] neg_hi:[1,0]
    v_pk_mul_f32 v[166:167], v[166:167], v[150:151] neg_lo:[1,0] neg_hi:[1,0]
    v_pk_mul_f32 v[168:169], v[168:169], v[152:153] neg_lo:[1,0] neg_hi:[1,0]
    v_pk_mul_f32 v[170:171], v[170:171], v[154:155] neg_lo:[1,0] neg_hi:[1,0]
    v_pk_mul_f32 v[172:173], v[172:173], v[156:157] neg_lo:[1,0] neg_hi:[1,0]
    v_pk_mul_f32 v[174:175], v[174:175], v[158:159] neg_lo:[1,0] neg_hi:[1,0]
    v_pk_mul_f32 v[176:177], v[176:177], v[160:161] neg_lo:[1,0] neg_hi:[1,0]
    v_pk_mul_f32 v[178:179], v[178:179], v[162:163] neg_lo:[1,0] neg_hi:[1,0]
    v_pk_add_f32 v[180:181], v[180:181], s[66:67]
    v_pk_add_f32 v[182:183], v[182:183], s[66:67]
    v_pk_add_f32 v[184:185], v[184:185], s[66:67]
    v_pk_add_f32 v[186:187], v[186:187], s[66:67]
    v_pk_add_f32 v[188:189], v[188:189], s[66:67]
    v_pk_add_f32 v[190:191], v[190:191], s[66:67]
    v_pk_add_f32 v[192:193], v[192:193], s[66:67]
    v_pk_add_f32 v[194:195], v[194:195], s[66:67]
    v_mfma_f32_32x32x16_bf16 v[116:131], a[192:195], a[196:199], 0
    ds_read_u16 a216, v17 offset:256
    ds_read_b64_tr_b16 a[186:187], v18 offset:28928
    ds_read_b64_tr_b16 a[36:37], v5 offset:15360
    v_cvt_pk_bf16_f32 v212, v196, v197
    v_cvt_pk_bf16_f32 v213, v198, v199
    v_cvt_pk_bf16_f32 v214, v200, v201
    v_mfma_f32_32x32x16_bf16 v[116:131], a[0:3], a[96:99], v[116:131]
    ds_read_u16 a218, v17 offset:288
    ds_read_b64_tr_b16 a[176:177], v16 offset:32768
    ds_read_b64_tr_b16 a[38:39], v5 offset:16896
    v_cvt_pk_bf16_f32 v215, v202, v203
    v_cvt_pk_bf16_f32 v216, v204, v205
    v_cvt_pk_bf16_f32 v217, v206, v207
    v_mfma_f32_32x32x16_bf16 v[116:131], a[4:7], a[100:103], v[116:131]
    ds_read_b64_tr_b16 a[168:169], v16 offset:24576
    ds_read_b64_tr_b16 a[178:179], v16 offset:33024
    ds_read_b64_tr_b16 a[40:41], v5 offset:15424
    v_cvt_pk_bf16_f32 v218, v208, v209
    v_cvt_pk_bf16_f32 v219, v210, v211
    v_rcp_f32_e64 v196, v180
    v_mfma_f32_32x32x16_bf16 v[116:131], a[8:11], a[104:107], v[116:131]
    ds_read_b64_tr_b16 a[170:171], v16 offset:24832
    ds_read_b64_tr_b16 a[188:189], v18 offset:32768
    ds_read_b64_tr_b16 a[42:43], v5 offset:16960
    v_rcp_f32_e64 v197, v181
    v_mfma_f32_32x32x16_bf16 v[116:131], a[12:15], a[108:111], v[116:131]
    ds_read_b64_tr_b16 a[180:181], v18 offset:24576
    ds_read_b64_tr_b16 a[190:191], v18 offset:33024
    ds_read_b64_tr_b16 a[44:45], v5 offset:15488
    v_rcp_f32 v198, v182
    v_mul_f32 v196, v196, v132
    v_mfma_f32_32x32x16_bf16 v[116:131], a[16:19], a[112:115], v[116:131]
    ds_read_b64_tr_b16 a[182:183], v18 offset:24832
    ds_read_b64_tr_b16 a[26:27], v5 offset:13824
    ds_read_b64_tr_b16 a[46:47], v5 offset:17024
    v_rcp_f32 v199, v183
    v_mul_f32 v197, v197, v133
    v_mfma_f32_32x32x16_bf16 v[116:131], a[20:23], a[116:119], v[116:131]
    ds_read_b64_tr_b16 a[172:173], v16 offset:28672
    ds_read_b64_tr_b16 a[28:29], v5 offset:12352
    v_rcp_f32 v200, v184
    v_rcp_f32 v201, v185
    v_mfma_f32_32x32x16_bf16 v[20:35], a[48:51], v[212:215], v[20:35]
    ds_read_b64_tr_b16 a[174:175], v16 offset:28928
    ds_read_b64_tr_b16 a[30:31], v5 offset:13888
    v_rcp_f32 v202, v186
    v_rcp_f32 v203, v187
    v_mfma_f32_32x32x16_bf16 v[36:51], a[52:55], v[212:215], v[36:51]
    ds_read_b64_tr_b16 a[184:185], v18 offset:28672
    ds_read_b64_tr_b16 a[32:33], v5 offset:12416
    v_rcp_f32 v204, v188
    v_rcp_f32 v205, v189
    v_mfma_f32_32x32x16_bf16 v[52:67], a[56:59], v[212:215], v[52:67]
    ds_read_b64_tr_b16 a[24:25], v5 offset:12288
    ds_read_b64_tr_b16 a[34:35], v5 offset:13952
    v_rcp_f32 v206, v190
    v_rcp_f32 v207, v191
    v_mfma_f32_32x32x16_bf16 v[20:35], a[60:63], v[216:219], v[20:35]
    v_rcp_f32 v208, v192
    v_rcp_f32 v209, v193
    v_rcp_f32_e64 v210, v194
    v_mfma_f32_32x32x16_bf16 v[36:51], a[64:67], v[216:219], v[36:51]
    v_rcp_f32 v211, v195
    v_exp_f32 v180, v164
    v_exp_f32_e64 v181, v165
    v_mfma_f32_32x32x16_bf16 v[52:67], a[68:71], v[216:219], v[52:67]
    s_waitcnt lgkmcnt(3)
    v_exp_f32 v182, v166
    v_exp_f32 v183, v167
    v_exp_f32 v184, v168
    v_mfma_f32_16x16x32_bf16 v[224:227], a[216:219], a[208:211], v[224:227]
    v_exp_f32_e64 v185, v169
    v_mfma_f32_16x16x32_bf16 v[224:227], a[168:171], a[144:147], v[224:227]
    v_exp_f32_e64 v186, v170
    v_mfma_f32_16x16x32_bf16 v[224:227], a[172:175], a[148:151], v[224:227]
    v_exp_f32_e64 v187, v171
    v_mfma_f32_16x16x32_bf16 v[224:227], a[176:179], a[152:155], v[224:227]
    v_exp_f32_e64 v188, v172
    v_mfma_f32_16x16x32_bf16 v[224:227], a[218:221], a[212:215], v[224:227]
    v_exp_f32_e64 v189, v173
    v_mfma_f32_16x16x32_bf16 v[224:227], a[180:183], a[156:159], v[224:227]
    v_exp_f32_e64 v190, v174
    v_mfma_f32_16x16x32_bf16 v[224:227], a[184:187], a[160:163], v[224:227]
    v_exp_f32_e64 v191, v175
    v_mfma_f32_16x16x32_bf16 v[224:227], a[188:191], a[164:167], v[224:227]
    s_waitcnt lgkmcnt(0)
    v_exp_f32 v192, v176
    v_exp_f32 v193, v177
    v_exp_f32 v194, v178
    v_exp_f32 v195, v179
    v_mul_f32 v198, v198, v134
    v_mul_f32_e64 v199, v199, v135
    v_pk_fma_f32 v[164:165], v[116:117], v[116:117], s[64:65]
    v_pk_fma_f32 v[166:167], v[118:119], v[118:119], s[64:65]
    v_pk_fma_f32 v[168:169], v[120:121], v[120:121], s[64:65]
    v_pk_fma_f32 v[170:171], v[122:123], v[122:123], s[64:65]
    v_pk_fma_f32 v[172:173], v[124:125], v[124:125], s[64:65]
    v_pk_fma_f32 v[174:175], v[126:127], v[126:127], s[64:65]
    v_pk_fma_f32 v[176:177], v[128:129], v[128:129], s[64:65]
    v_pk_fma_f32 v[178:179], v[130:131], v[130:131], s[64:65]
    v_pk_mul_f32 v[200:201], v[200:201], v[136:137]
    v_pk_mul_f32 v[202:203], v[202:203], v[138:139]
    v_pk_mul_f32 v[204:205], v[204:205], v[140:141]
    v_pk_mul_f32 v[206:207], v[206:207], v[142:143]
    v_pk_mul_f32 v[208:209], v[208:209], v[144:145]
    v_pk_mul_f32 v[210:211], v[210:211], v[146:147]
    v_pk_mul_f32 v[164:165], v[164:165], v[116:117] neg_lo:[1,0] neg_hi:[1,0]
    v_pk_mul_f32 v[166:167], v[166:167], v[118:119] neg_lo:[1,0] neg_hi:[1,0]
    v_pk_mul_f32 v[168:169], v[168:169], v[120:121] neg_lo:[1,0] neg_hi:[1,0]
    v_pk_mul_f32 v[170:171], v[170:171], v[122:123] neg_lo:[1,0] neg_hi:[1,0]
    v_pk_mul_f32 v[172:173], v[172:173], v[124:125] neg_lo:[1,0] neg_hi:[1,0]
    v_pk_mul_f32 v[174:175], v[174:175], v[126:127] neg_lo:[1,0] neg_hi:[1,0]
    v_pk_mul_f32 v[176:177], v[176:177], v[128:129] neg_lo:[1,0] neg_hi:[1,0]
    v_pk_mul_f32 v[178:179], v[178:179], v[130:131] neg_lo:[1,0] neg_hi:[1,0]
    v_pk_add_f32 v[180:181], v[180:181], s[66:67]
    v_pk_add_f32 v[182:183], v[182:183], s[66:67]
    v_pk_add_f32 v[184:185], v[184:185], s[66:67]
    v_pk_add_f32 v[186:187], v[186:187], s[66:67]
    v_pk_add_f32 v[188:189], v[188:189], s[66:67]
    v_pk_add_f32 v[190:191], v[190:191], s[66:67]
    v_pk_add_f32 v[192:193], v[192:193], s[66:67]
    v_pk_add_f32 v[194:195], v[194:195], s[66:67]
    v_mfma_f32_32x32x16_bf16 v[132:147], a[192:195], a[196:199], 0
    ds_read_u16 a192, v6 offset:512
    ds_read_b64_tr_b16 a[48:49], v5 offset:24576
    ds_read_b64_tr_b16 a[62:63], v5 offset:29184
    v_cvt_pk_bf16_f32 v212, v196, v197
    v_cvt_pk_bf16_f32 v213, v198, v199
    v_cvt_pk_bf16_f32 v214, v200, v201
    v_cvt_pk_bf16_f32 v215, v202, v203
    v_mfma_f32_32x32x16_bf16 v[132:147], a[0:3], a[72:75], v[132:147]
    ds_read_b64_tr_b16 a[0:1], v2 offset:12288
    ds_read_b64_tr_b16 a[2:3], v2 offset:12544
    ds_read_b64_tr_b16 a[64:65], v5 offset:27712
    v_cvt_pk_bf16_f32 v216, v204, v205
    v_cvt_pk_bf16_f32 v217, v206, v207
    v_cvt_pk_bf16_f32 v218, v208, v209
    v_cvt_pk_bf16_f32 v219, v210, v211
    v_mfma_f32_32x32x16_bf16 v[132:147], a[4:7], a[76:79], v[132:147]
    ds_read_b64_tr_b16 a[4:5], v2 offset:14336
    ds_read_b64_tr_b16 a[6:7], v2 offset:14592
    ds_read_b64_tr_b16 a[66:67], v5 offset:29248
    v_rcp_f32 v196, v180
    v_rcp_f32 v197, v181
    v_mfma_f32_32x32x16_bf16 v[132:147], a[8:11], a[80:83], v[132:147]
    ds_read_b64_tr_b16 a[8:9], v2 offset:16384
    ds_read_b64_tr_b16 a[10:11], v2 offset:16640
    ds_read_b64_tr_b16 a[68:69], v5 offset:27776
    v_rcp_f32 v198, v182
    v_rcp_f32 v199, v183
    v_mfma_f32_32x32x16_bf16 v[132:147], a[12:15], a[84:87], v[132:147]
    ds_read_b64_tr_b16 a[12:13], v2 offset:18432
    ds_read_b64_tr_b16 a[50:51], v5 offset:26112
    ds_read_b64_tr_b16 a[70:71], v5 offset:29312
    v_rcp_f32 v200, v184
    v_rcp_f32 v201, v185
    v_rcp_f32_e64 v202, v186
    v_mfma_f32_32x32x16_bf16 v[132:147], a[16:19], a[88:91], v[132:147]
    ds_read_b64_tr_b16 a[16:17], v2 offset:20480
    ds_read_b64_tr_b16 a[52:53], v5 offset:24640
    v_rcp_f32 v203, v187
    v_rcp_f32 v204, v188
    v_mfma_f32_32x32x16_bf16 v[132:147], a[20:23], a[92:95], v[132:147]
    ds_read_b64_tr_b16 a[20:21], v2 offset:22528
    ds_read_b64_tr_b16 a[54:55], v5 offset:26176
    v_rcp_f32 v205, v189
    v_rcp_f32 v206, v190
    v_rcp_f32_e64 v207, v191
    v_mfma_f32_32x32x16_bf16 v[20:35], a[24:27], v[212:215], v[20:35]
    ds_read_b64_tr_b16 a[22:23], v2 offset:22784
    ds_read_b64_tr_b16 a[56:57], v5 offset:24704
    v_rcp_f32 v208, v192
    v_rcp_f32 v209, v193
    v_mfma_f32_32x32x16_bf16 v[36:51], a[28:31], v[212:215], v[36:51]
    ds_read_b64_tr_b16 a[18:19], v2 offset:20736
    ds_read_b64_tr_b16 a[58:59], v5 offset:26240
    v_rcp_f32 v210, v194
    v_rcp_f32 v211, v195
    v_exp_f32_e64 v180, v164
    v_mfma_f32_32x32x16_bf16 v[52:67], a[32:35], v[212:215], v[52:67]
    ds_read_b64_tr_b16 a[14:15], v2 offset:18688
    ds_read_b64_tr_b16 a[60:61], v5 offset:27648
    v_exp_f32 v181, v165
    v_exp_f32 v182, v166
    v_exp_f32_e64 v183, v167
    v_mfma_f32_32x32x16_bf16 v[20:35], a[36:39], v[216:219], v[20:35]
    v_exp_f32 v184, v168
    v_exp_f32 v185, v169
    v_exp_f32_e64 v186, v170
    v_mfma_f32_32x32x16_bf16 v[36:51], a[40:43], v[216:219], v[36:51]
    v_exp_f32 v187, v171
    v_exp_f32 v188, v172
    v_exp_f32 v189, v173
    v_exp_f32 v190, v174
    v_mfma_f32_32x32x16_bf16 v[52:67], a[44:47], v[216:219], v[52:67]
    s_waitcnt lgkmcnt(0)
    v_exp_f32 v191, v175
    v_exp_f32 v192, v176
    v_exp_f32 v193, v177
    v_exp_f32 v194, v178
    v_exp_f32 v195, v179
    v_pk_fma_f32 v[164:165], v[132:133], v[132:133], s[64:65]
    v_pk_fma_f32 v[166:167], v[134:135], v[134:135], s[64:65]
    v_pk_fma_f32 v[168:169], v[136:137], v[136:137], s[64:65]
    v_pk_fma_f32 v[170:171], v[138:139], v[138:139], s[64:65]
    v_pk_fma_f32 v[172:173], v[140:141], v[140:141], s[64:65]
    v_pk_fma_f32 v[174:175], v[142:143], v[142:143], s[64:65]
    v_pk_fma_f32 v[176:177], v[144:145], v[144:145], s[64:65]
    v_pk_fma_f32 v[178:179], v[146:147], v[146:147], s[64:65]
    v_pk_mul_f32 v[196:197], v[196:197], v[148:149]
    v_pk_mul_f32 v[198:199], v[198:199], v[150:151]
    v_pk_mul_f32 v[200:201], v[200:201], v[152:153]
    v_pk_mul_f32 v[202:203], v[202:203], v[154:155]
    v_pk_mul_f32 v[204:205], v[204:205], v[156:157]
    v_pk_mul_f32 v[206:207], v[206:207], v[158:159]
    v_pk_mul_f32 v[208:209], v[208:209], v[160:161]
    v_pk_mul_f32 v[210:211], v[210:211], v[162:163]
    v_pk_mul_f32 v[164:165], v[164:165], v[132:133] neg_lo:[1,0] neg_hi:[1,0]
    v_pk_mul_f32 v[166:167], v[166:167], v[134:135] neg_lo:[1,0] neg_hi:[1,0]
    v_pk_mul_f32 v[168:169], v[168:169], v[136:137] neg_lo:[1,0] neg_hi:[1,0]
    v_pk_mul_f32 v[170:171], v[170:171], v[138:139] neg_lo:[1,0] neg_hi:[1,0]
    v_pk_mul_f32 v[172:173], v[172:173], v[140:141] neg_lo:[1,0] neg_hi:[1,0]
    v_pk_mul_f32 v[174:175], v[174:175], v[142:143] neg_lo:[1,0] neg_hi:[1,0]
    v_pk_mul_f32 v[176:177], v[176:177], v[144:145] neg_lo:[1,0] neg_hi:[1,0]
    v_pk_mul_f32 v[178:179], v[178:179], v[146:147] neg_lo:[1,0] neg_hi:[1,0]
    v_pk_add_f32 v[180:181], v[180:181], s[66:67]
    v_pk_add_f32 v[182:183], v[182:183], s[66:67]
    v_pk_add_f32 v[184:185], v[184:185], s[66:67]
    v_pk_add_f32 v[186:187], v[186:187], s[66:67]
    v_pk_add_f32 v[188:189], v[188:189], s[66:67]
    v_pk_add_f32 v[190:191], v[190:191], s[66:67]
    v_pk_add_f32 v[192:193], v[192:193], s[66:67]
    v_pk_add_f32 v[194:195], v[194:195], s[66:67]
    v_mfma_f32_32x32x16_bf16 v[148:163], a[192:195], a[196:199], 0
    ds_read_u16 a216, v17 offset:512
    ds_read_b64_tr_b16 a[186:187], v18 offset:53504
    ds_read_b64_tr_b16 a[36:37], v4 offset:3072
    v_cvt_pk_bf16_f32 v212, v196, v197
    v_cvt_pk_bf16_f32 v213, v198, v199
    v_cvt_pk_bf16_f32 v214, v200, v201
    v_mfma_f32_32x32x16_bf16 v[148:163], a[0:3], a[96:99], v[148:163]
    ds_read_u16 a218, v17 offset:544
    ds_read_b64_tr_b16 a[176:177], v16 offset:57344
    ds_read_b64_tr_b16 a[38:39], v4 offset:4608
    v_cvt_pk_bf16_f32 v215, v202, v203
    v_cvt_pk_bf16_f32 v216, v204, v205
    v_cvt_pk_bf16_f32 v217, v206, v207
    v_mfma_f32_32x32x16_bf16 v[148:163], a[4:7], a[100:103], v[148:163]
    ds_read_b64_tr_b16 a[168:169], v16 offset:49152
    ds_read_b64_tr_b16 a[178:179], v16 offset:57600
    ds_read_b64_tr_b16 a[40:41], v4 offset:3136
    v_cvt_pk_bf16_f32 v218, v208, v209
    v_cvt_pk_bf16_f32 v219, v210, v211
    v_rcp_f32_e64 v196, v180
    v_mfma_f32_32x32x16_bf16 v[148:163], a[8:11], a[104:107], v[148:163]
    ds_read_b64_tr_b16 a[170:171], v16 offset:49408
    ds_read_b64_tr_b16 a[188:189], v18 offset:57344
    ds_read_b64_tr_b16 a[42:43], v4 offset:4672
    v_rcp_f32_e64 v197, v181
    v_mfma_f32_32x32x16_bf16 v[148:163], a[12:15], a[108:111], v[148:163]
    ds_read_b64_tr_b16 a[180:181], v18 offset:49152
    ds_read_b64_tr_b16 a[190:191], v18 offset:57600
    ds_read_b64_tr_b16 a[44:45], v4 offset:3200
    v_rcp_f32 v198, v182
    v_mul_f32 v196, v196, v116
    v_mfma_f32_32x32x16_bf16 v[148:163], a[16:19], a[112:115], v[148:163]
    ds_read_b64_tr_b16 a[182:183], v18 offset:49408
    ds_read_b64_tr_b16 a[26:27], v4 offset:1536
    ds_read_b64_tr_b16 a[46:47], v4 offset:4736
    v_rcp_f32 v199, v183
    v_mul_f32 v197, v197, v117
    v_mfma_f32_32x32x16_bf16 v[148:163], a[20:23], a[116:119], v[148:163]
    ds_read_b64_tr_b16 a[172:173], v16 offset:53248
    ds_read_b64_tr_b16 a[28:29], v4 offset:64
    v_rcp_f32 v200, v184
    v_rcp_f32 v201, v185
    v_mfma_f32_32x32x16_bf16 v[20:35], a[48:51], v[212:215], v[20:35]
    ds_read_b64_tr_b16 a[174:175], v16 offset:53504
    ds_read_b64_tr_b16 a[30:31], v4 offset:1600
    v_rcp_f32 v202, v186
    v_rcp_f32 v203, v187
    v_mfma_f32_32x32x16_bf16 v[36:51], a[52:55], v[212:215], v[36:51]
    ds_read_b64_tr_b16 a[184:185], v18 offset:53248
    ds_read_b64_tr_b16 a[32:33], v4 offset:128
    v_rcp_f32 v204, v188
    v_rcp_f32 v205, v189
    v_mfma_f32_32x32x16_bf16 v[52:67], a[56:59], v[212:215], v[52:67]
    ds_read_b64_tr_b16 a[24:25], v4 offset:0
    ds_read_b64_tr_b16 a[34:35], v4 offset:1664
    v_rcp_f32 v206, v190
    v_rcp_f32 v207, v191
    v_mfma_f32_32x32x16_bf16 v[20:35], a[60:63], v[216:219], v[20:35]
    v_rcp_f32 v208, v192
    v_rcp_f32 v209, v193
    v_rcp_f32_e64 v210, v194
    v_mfma_f32_32x32x16_bf16 v[36:51], a[64:67], v[216:219], v[36:51]
    v_rcp_f32 v211, v195
    v_exp_f32 v180, v164
    v_exp_f32_e64 v181, v165
    v_mfma_f32_32x32x16_bf16 v[52:67], a[68:71], v[216:219], v[52:67]
    s_waitcnt lgkmcnt(3)
    v_exp_f32 v182, v166
    v_exp_f32 v183, v167
    v_exp_f32 v184, v168
    v_mfma_f32_16x16x32_bf16 v[228:231], a[216:219], a[200:203], 0
    v_exp_f32_e64 v185, v169
    v_mfma_f32_16x16x32_bf16 v[228:231], a[168:171], a[120:123], v[228:231]
    v_exp_f32_e64 v186, v170
    v_mfma_f32_16x16x32_bf16 v[228:231], a[172:175], a[124:127], v[228:231]
    v_exp_f32_e64 v187, v171
    v_mfma_f32_16x16x32_bf16 v[228:231], a[176:179], a[128:131], v[228:231]
    v_exp_f32_e64 v188, v172
    v_mfma_f32_16x16x32_bf16 v[228:231], a[218:221], a[204:207], v[228:231]
    v_exp_f32_e64 v189, v173
    v_mfma_f32_16x16x32_bf16 v[228:231], a[180:183], a[132:135], v[228:231]
    v_exp_f32_e64 v190, v174
    v_mfma_f32_16x16x32_bf16 v[228:231], a[184:187], a[136:139], v[228:231]
    v_exp_f32_e64 v191, v175
    v_mfma_f32_16x16x32_bf16 v[228:231], a[188:191], a[140:143], v[228:231]
    s_waitcnt lgkmcnt(0)
    v_exp_f32 v192, v176
    v_exp_f32 v193, v177
    v_exp_f32 v194, v178
    v_exp_f32 v195, v179
    v_mul_f32 v198, v198, v118
    v_mul_f32_e64 v199, v199, v119
    v_pk_fma_f32 v[164:165], v[148:149], v[148:149], s[64:65]
    v_pk_fma_f32 v[166:167], v[150:151], v[150:151], s[64:65]
    v_pk_fma_f32 v[168:169], v[152:153], v[152:153], s[64:65]
    v_pk_fma_f32 v[170:171], v[154:155], v[154:155], s[64:65]
    v_pk_fma_f32 v[172:173], v[156:157], v[156:157], s[64:65]
    v_pk_fma_f32 v[174:175], v[158:159], v[158:159], s[64:65]
    v_pk_fma_f32 v[176:177], v[160:161], v[160:161], s[64:65]
    v_pk_fma_f32 v[178:179], v[162:163], v[162:163], s[64:65]
    v_pk_mul_f32 v[200:201], v[200:201], v[120:121]
    v_pk_mul_f32 v[202:203], v[202:203], v[122:123]
    v_pk_mul_f32 v[204:205], v[204:205], v[124:125]
    v_pk_mul_f32 v[206:207], v[206:207], v[126:127]
    v_pk_mul_f32 v[208:209], v[208:209], v[128:129]
    v_pk_mul_f32 v[210:211], v[210:211], v[130:131]
    v_pk_mul_f32 v[164:165], v[164:165], v[148:149] neg_lo:[1,0] neg_hi:[1,0]
    v_pk_mul_f32 v[166:167], v[166:167], v[150:151] neg_lo:[1,0] neg_hi:[1,0]
    v_pk_mul_f32 v[168:169], v[168:169], v[152:153] neg_lo:[1,0] neg_hi:[1,0]
    v_pk_mul_f32 v[170:171], v[170:171], v[154:155] neg_lo:[1,0] neg_hi:[1,0]
    v_pk_mul_f32 v[172:173], v[172:173], v[156:157] neg_lo:[1,0] neg_hi:[1,0]
    v_pk_mul_f32 v[174:175], v[174:175], v[158:159] neg_lo:[1,0] neg_hi:[1,0]
    v_pk_mul_f32 v[176:177], v[176:177], v[160:161] neg_lo:[1,0] neg_hi:[1,0]
    v_pk_mul_f32 v[178:179], v[178:179], v[162:163] neg_lo:[1,0] neg_hi:[1,0]
    v_pk_add_f32 v[180:181], v[180:181], s[66:67]
L_pad4:
    s_cbranch_execz L_body
    s_nop 0
    v_pk_add_f32 v[182:183], v[182:183], s[66:67]
    v_pk_add_f32 v[184:185], v[184:185], s[66:67]
    v_pk_add_f32 v[186:187], v[186:187], s[66:67]
    v_pk_add_f32 v[188:189], v[188:189], s[66:67]
    v_pk_add_f32 v[190:191], v[190:191], s[66:67]
    v_pk_add_f32 v[192:193], v[192:193], s[66:67]
    v_pk_add_f32 v[194:195], v[194:195], s[66:67]
    v_pk_fma_f32 v[232:233], v[224:225], v[224:225], s[64:65]
    v_pk_fma_f32 v[234:235], v[226:227], v[226:227], s[64:65]
    v_pk_fma_f32 v[236:237], v[228:229], v[228:229], s[64:65]
    v_pk_fma_f32 v[238:239], v[230:231], v[230:231], s[64:65]
    v_pk_mul_f32 v[232:233], v[232:233], v[224:225] neg_lo:[1,0] neg_hi:[1,0]
    v_pk_mul_f32 v[234:235], v[234:235], v[226:227] neg_lo:[1,0] neg_hi:[1,0]
    v_pk_mul_f32 v[236:237], v[236:237], v[228:229] neg_lo:[1,0] neg_hi:[1,0]
    v_pk_mul_f32 v[238:239], v[238:239], v[230:231] neg_lo:[1,0] neg_hi:[1,0]
    v_mfma_f32_32x32x16_bf16 v[116:131], a[192:195], a[196:199], 0
    ds_read_u16 a192, v6 offset:640
    v_cvt_pk_bf16_f32 v212, v196, v197
    v_cvt_pk_bf16_f32 v213, v198, v199
    v_cvt_pk_bf16_f32 v214, v200, v201
    v_cvt_pk_bf16_f32 v215, v202, v203
    v_cvt_pk_bf16_f32 v216, v204, v205
    v_cvt_pk_bf16_f32 v217, v206, v207
    v_mfma_f32_32x32x16_bf16 v[116:131], a[0:3], a[72:75], v[116:131]
    ds_read_b64_tr_b16 a[0:1], v2 offset:24576
    ds_read_b64_tr_b16 a[2:3], v2 offset:24832
    v_cvt_pk_bf16_f32 v218, v208, v209
    v_cvt_pk_bf16_f32 v219, v210, v211
    v_rcp_f32 v196, v180
    v_rcp_f32 v197, v181
    v_mfma_f32_32x32x16_bf16 v[116:131], a[4:7], a[76:79], v[116:131]
    ds_read_b64_tr_b16 a[4:5], v2 offset:26624
    ds_read_b64_tr_b16 a[6:7], v2 offset:26880
    v_rcp_f32 v198, v182
    v_rcp_f32 v199, v183
    v_rcp_f32_e64 v200, v184
    v_mfma_f32_32x32x16_bf16 v[116:131], a[8:11], a[80:83], v[116:131]
    ds_read_b64_tr_b16 a[8:9], v2 offset:28672
    ds_read_b64_tr_b16 a[10:11], v2 offset:28928
    v_rcp_f32 v201, v185
    v_rcp_f32 v202, v186
    v_rcp_f32_e64 v203, v187
    v_mfma_f32_32x32x16_bf16 v[116:131], a[12:15], a[84:87], v[116:131]
    ds_read_b64_tr_b16 a[12:13], v2 offset:30720
    v_rcp_f32 v204, v188
    v_rcp_f32 v205, v189
    v_rcp_f32_e64 v206, v190
    v_mfma_f32_32x32x16_bf16 v[116:131], a[16:19], a[88:91], v[116:131]
    ds_read_b64_tr_b16 a[16:17], v2 offset:32768
    v_rcp_f32 v207, v191
    v_rcp_f32 v208, v192
    v_rcp_f32 v209, v193
    v_rcp_f32 v210, v194
    v_mfma_f32_32x32x16_bf16 v[116:131], a[20:23], a[92:95], v[116:131]
    ds_read_b64_tr_b16 a[20:21], v2 offset:34816
    v_rcp_f32 v211, v195
    v_exp_f32 v180, v164
    v_exp_f32_e64 v181, v165
    v_mfma_f32_32x32x16_bf16 v[68:83], a[24:27], v[212:215], v[68:83]
    ds_read_b64_tr_b16 a[22:23], v2 offset:35072
    v_exp_f32 v182, v166
    v_exp_f32 v183, v167
    v_exp_f32_e64 v184, v168
    v_mfma_f32_32x32x16_bf16 v[84:99], a[28:31], v[212:215], v[84:99]
    ds_read_b64_tr_b16 a[18:19], v2 offset:33024
    v_exp_f32 v185, v169
    v_exp_f32 v186, v170
    v_exp_f32 v187, v171
    v_exp_f32 v188, v172
    v_mfma_f32_32x32x16_bf16 v[100:115], a[32:35], v[212:215], v[100:115]
    ds_read_b64_tr_b16 a[14:15], v2 offset:30976
    v_exp_f32 v189, v173
    v_exp_f32 v190, v174
    v_exp_f32_e64 v191, v175
    v_mfma_f32_32x32x16_bf16 v[68:83], a[36:39], v[216:219], v[68:83]
    v_exp_f32 v192, v176
    v_exp_f32 v193, v177
    v_exp_f32 v194, v178
    v_exp_f32 v195, v179
    v_mfma_f32_32x32x16_bf16 v[84:99], a[40:43], v[216:219], v[84:99]
    v_exp_f32 v232, v232
    v_exp_f32 v233, v233
    v_exp_f32 v234, v234
    v_exp_f32 v235, v235
    v_mfma_f32_32x32x16_bf16 v[100:115], a[44:47], v[216:219], v[100:115]
    s_waitcnt lgkmcnt(0)
    v_exp_f32 v236, v236
    v_exp_f32 v237, v237
    v_exp_f32 v238, v238
    v_exp_f32_e64 v239, v239
    v_subrev_u32 v5, 36864, v5
    v_add_u32 v3, 36864, v3
    v_pk_fma_f32 v[164:165], v[116:117], v[116:117], s[64:65]
    v_pk_fma_f32 v[166:167], v[118:119], v[118:119], s[64:65]
    v_pk_fma_f32 v[168:169], v[120:121], v[120:121], s[64:65]
    v_pk_fma_f32 v[170:171], v[122:123], v[122:123], s[64:65]
    v_pk_fma_f32 v[172:173], v[124:125], v[124:125], s[64:65]
    v_pk_fma_f32 v[174:175], v[126:127], v[126:127], s[64:65]
    v_pk_fma_f32 v[176:177], v[128:129], v[128:129], s[64:65]
    v_pk_fma_f32 v[178:179], v[130:131], v[130:131], s[64:65]
    v_pk_mul_f32 v[196:197], v[196:197], v[132:133]
    v_pk_mul_f32 v[198:199], v[198:199], v[134:135]
    v_pk_mul_f32 v[200:201], v[200:201], v[136:137]
    v_pk_mul_f32 v[202:203], v[202:203], v[138:139]
    v_pk_mul_f32 v[204:205], v[204:205], v[140:141]
    v_pk_mul_f32 v[206:207], v[206:207], v[142:143]
    v_pk_mul_f32 v[208:209], v[208:209], v[144:145]
    v_pk_mul_f32 v[210:211], v[210:211], v[146:147]
    v_pk_mul_f32 v[164:165], v[164:165], v[116:117] neg_lo:[1,0] neg_hi:[1,0]
    v_pk_mul_f32 v[166:167], v[166:167], v[118:119] neg_lo:[1,0] neg_hi:[1,0]
    v_pk_mul_f32 v[168:169], v[168:169], v[120:121] neg_lo:[1,0] neg_hi:[1,0]
    v_pk_mul_f32 v[170:171], v[170:171], v[122:123] neg_lo:[1,0] neg_hi:[1,0]
    v_pk_mul_f32 v[172:173], v[172:173], v[124:125] neg_lo:[1,0] neg_hi:[1,0]
    v_pk_mul_f32 v[174:175], v[174:175], v[126:127] neg_lo:[1,0] neg_hi:[1,0]
    v_pk_mul_f32 v[176:177], v[176:177], v[128:129] neg_lo:[1,0] neg_hi:[1,0]
    v_pk_mul_f32 v[178:179], v[178:179], v[130:131] neg_lo:[1,0] neg_hi:[1,0]
    v_pk_add_f32 v[180:181], v[180:181], s[66:67]
    v_pk_add_f32 v[182:183], v[182:183], s[66:67]
    v_pk_add_f32 v[184:185], v[184:185], s[66:67]
    v_pk_add_f32 v[186:187], v[186:187], s[66:67]
    v_pk_add_f32 v[188:189], v[188:189], s[66:67]
    v_pk_add_f32 v[190:191], v[190:191], s[66:67]
    v_pk_add_f32 v[192:193], v[192:193], s[66:67]
    v_pk_add_f32 v[194:195], v[194:195], s[66:67]
    v_pk_add_f32 v[232:233], v[232:233], s[66:67]
    v_pk_add_f32 v[234:235], v[234:235], s[66:67]
    v_pk_add_f32 v[236:237], v[236:237], s[66:67]
    v_pk_add_f32 v[238:239], v[238:239], s[66:67]
    v_mfma_f32_32x32x16_bf16 v[132:147], a[192:195], a[196:199], 0
    ds_read_b64_tr_b16 a[48:49], v4 offset:12288
    ds_read_b64_tr_b16 a[68:69], v4 offset:15488
    v_cvt_pk_bf16_f32 v212, v196, v197
    v_cvt_pk_bf16_f32 v213, v198, v199
    v_cvt_pk_bf16_f32 v214, v200, v201
    v_cvt_pk_bf16_f32 v215, v202, v203
    v_cvt_pk_bf16_f32 v216, v204, v205
    v_mfma_f32_32x32x16_bf16 v[132:147], a[0:3], a[96:99], v[132:147]
    ds_read_b64_tr_b16 a[50:51], v4 offset:13824
    ds_read_b64_tr_b16 a[70:71], v4 offset:17024
    v_cvt_pk_bf16_f32 v217, v206, v207
    v_cvt_pk_bf16_f32 v218, v208, v209
    v_cvt_pk_bf16_f32 v219, v210, v211
    v_rcp_f32_e64 v196, v180
    v_mfma_f32_32x32x16_bf16 v[132:147], a[4:7], a[100:103], v[132:147]
    ds_read_b64_tr_b16 a[52:53], v4 offset:12352
    v_rcp_f32 v197, v181
    v_rcp_f32 v198, v182
    v_rcp_f32 v199, v183
    v_rcp_f32 v200, v184
    v_mfma_f32_32x32x16_bf16 v[132:147], a[8:11], a[104:107], v[132:147]
    ds_read_b64_tr_b16 a[54:55], v4 offset:13888
    v_rcp_f32 v201, v185
    v_rcp_f32 v202, v186
    v_rcp_f32_e64 v203, v187
    v_mfma_f32_32x32x16_bf16 v[132:147], a[12:15], a[108:111], v[132:147]
    ds_read_b64_tr_b16 a[56:57], v4 offset:12416
    v_rcp_f32 v204, v188
    v_rcp_f32 v205, v189
    v_rcp_f32_e64 v206, v190
    v_mfma_f32_32x32x16_bf16 v[132:147], a[16:19], a[112:115], v[132:147]
    ds_read_b64_tr_b16 a[58:59], v4 offset:13952
    v_rcp_f32 v207, v191
    v_rcp_f32 v208, v192
    v_rcp_f32_e64 v209, v193
    v_mfma_f32_32x32x16_bf16 v[132:147], a[20:23], a[116:119], v[132:147]
    ds_read_b64_tr_b16 a[60:61], v4 offset:15360
    v_rcp_f32 v210, v194
    v_rcp_f32 v211, v195
    v_exp_f32 v180, v164
    v_exp_f32 v181, v165
    v_mfma_f32_32x32x16_bf16 v[20:35], a[24:27], v[212:215], v[20:35]
    ds_read_b64_tr_b16 a[62:63], v4 offset:16896
    v_exp_f32 v182, v166
    v_exp_f32 v183, v167
    v_exp_f32_e64 v184, v168
    v_mfma_f32_32x32x16_bf16 v[36:51], a[28:31], v[212:215], v[36:51]
    ds_read_b64_tr_b16 a[64:65], v4 offset:15424
    v_exp_f32 v185, v169
    v_exp_f32 v186, v170
    v_exp_f32_e64 v187, v171
    v_mfma_f32_32x32x16_bf16 v[52:67], a[32:35], v[212:215], v[52:67]
    ds_read_b64_tr_b16 a[66:67], v4 offset:16960
    v_exp_f32 v188, v172
    v_exp_f32 v189, v173
    v_exp_f32_e64 v190, v174
    v_mfma_f32_32x32x16_bf16 v[20:35], a[36:39], v[216:219], v[20:35]
    v_exp_f32 v191, v175
    v_exp_f32 v192, v176
    v_exp_f32 v193, v177
    v_exp_f32 v194, v178
    v_mfma_f32_32x32x16_bf16 v[36:51], a[40:43], v[216:219], v[36:51]
    v_exp_f32 v195, v179
    v_rcp_f32 v232, v232
    v_rcp_f32 v233, v233
    v_rcp_f32 v234, v234
    v_mfma_f32_32x32x16_bf16 v[52:67], a[44:47], v[216:219], v[52:67]
    s_waitcnt lgkmcnt(0)
    v_rcp_f32 v235, v235
    v_rcp_f32 v236, v236
    v_rcp_f32 v237, v237
    v_rcp_f32 v238, v238
    v_rcp_f32 v239, v239
    v_pk_fma_f32 v[164:165], v[132:133], v[132:133], s[64:65]
    v_pk_fma_f32 v[166:167], v[134:135], v[134:135], s[64:65]
    v_pk_fma_f32 v[168:169], v[136:137], v[136:137], s[64:65]
    v_pk_fma_f32 v[170:171], v[138:139], v[138:139], s[64:65]
    v_pk_fma_f32 v[172:173], v[140:141], v[140:141], s[64:65]
    v_pk_fma_f32 v[174:175], v[142:143], v[142:143], s[64:65]
    v_pk_fma_f32 v[176:177], v[144:145], v[144:145], s[64:65]
    v_pk_fma_f32 v[178:179], v[146:147], v[146:147], s[64:65]
    v_pk_mul_f32 v[196:197], v[196:197], v[148:149]
    v_pk_mul_f32 v[198:199], v[198:199], v[150:151]
    v_pk_mul_f32 v[200:201], v[200:201], v[152:153]
    v_pk_mul_f32 v[202:203], v[202:203], v[154:155]
    v_pk_mul_f32 v[204:205], v[204:205], v[156:157]
    v_pk_mul_f32 v[206:207], v[206:207], v[158:159]
    v_pk_mul_f32 v[208:209], v[208:209], v[160:161]
    v_pk_mul_f32 v[210:211], v[210:211], v[162:163]
    v_pk_mul_f32 v[164:165], v[164:165], v[132:133] neg_lo:[1,0] neg_hi:[1,0]
    v_pk_mul_f32 v[166:167], v[166:167], v[134:135] neg_lo:[1,0] neg_hi:[1,0]
    v_pk_mul_f32 v[168:169], v[168:169], v[136:137] neg_lo:[1,0] neg_hi:[1,0]
    v_pk_mul_f32 v[170:171], v[170:171], v[138:139] neg_lo:[1,0] neg_hi:[1,0]
    v_pk_mul_f32 v[172:173], v[172:173], v[140:141] neg_lo:[1,0] neg_hi:[1,0]
    v_pk_mul_f32 v[174:175], v[174:175], v[142:143] neg_lo:[1,0] neg_hi:[1,0]
    v_pk_mul_f32 v[176:177], v[176:177], v[144:145] neg_lo:[1,0] neg_hi:[1,0]
    v_pk_mul_f32 v[178:179], v[178:179], v[146:147] neg_lo:[1,0] neg_hi:[1,0]
    v_pk_add_f32 v[180:181], v[180:181], s[66:67]
    v_pk_add_f32 v[182:183], v[182:183], s[66:67]
    v_pk_add_f32 v[184:185], v[184:185], s[66:67]
    v_pk_add_f32 v[186:187], v[186:187], s[66:67]
    v_pk_add_f32 v[188:189], v[188:189], s[66:67]
    v_pk_add_f32 v[190:191], v[190:191], s[66:67]
    v_pk_add_f32 v[192:193], v[192:193], s[66:67]
    v_pk_add_f32 v[194:195], v[194:195], s[66:67]
    v_pk_mul_f32 v[232:233], v[232:233], v[224:225]
    v_pk_mul_f32 v[234:235], v[234:235], v[226:227]
    v_pk_mul_f32 v[236:237], v[236:237], v[228:229]
    v_pk_mul_f32 v[238:239], v[238:239], v[230:231]
    v_mfma_f32_32x32x16_bf16 v[148:163], a[192:195], a[196:199], 0
    ds_read_u16 a192, v7 offset:384
    v_cvt_pk_bf16_f32 v212, v196, v197
    v_cvt_pk_bf16_f32 v213, v198, v199
    v_cvt_pk_bf16_f32 v214, v200, v201
    v_cvt_pk_bf16_f32 v215, v202, v203
    v_cvt_pk_bf16_f32 v216, v204, v205
    v_mfma_f32_32x32x16_bf16 v[148:163], a[0:3], a[72:75], v[148:163]
    ds_read_b64_tr_b16 a[0:1], v3 offset:0
    ds_read_b64_tr_b16 a[2:3], v3 offset:256
    v_cvt_pk_bf16_f32 v217, v206, v207
    v_cvt_pk_bf16_f32 v218, v208, v209
    v_cvt_pk_bf16_f32 v219, v210, v211
    v_rcp_f32_e64 v196, v180
    v_mfma_f32_32x32x16_bf16 v[148:163], a[4:7], a[76:79], v[148:163]
    ds_read_b64_tr_b16 a[4:5], v3 offset:2048
    ds_read_b64_tr_b16 a[6:7], v3 offset:2304
    v_rcp_f32 v197, v181
    v_rcp_f32 v198, v182
    v_mfma_f32_32x32x16_bf16 v[148:163], a[8:11], a[80:83], v[148:163]
    ds_read_b64_tr_b16 a[8:9], v3 offset:4096
    ds_read_b64_tr_b16 a[10:11], v3 offset:4352
    v_rcp_f32 v199, v183
    v_rcp_f32 v200, v184
    v_rcp_f32_e64 v201, v185
    v_mfma_f32_32x32x16_bf16 v[148:163], a[12:15], a[84:87], v[148:163]
    ds_read_b64_tr_b16 a[12:13], v3 offset:6144
    v_rcp_f32 v202, v186
    v_rcp_f32 v203, v187
    v_mfma_f32_32x32x16_bf16 v[148:163], a[16:19], a[88:91], v[148:163]
    ds_read_b64_tr_b16 a[16:17], v3 offset:8192
    v_rcp_f32 v204, v188
    v_rcp_f32 v205, v189
    v_rcp_f32_e64 v206, v190
    v_mfma_f32_32x32x16_bf16 v[148:163], a[20:23], a[92:95], v[148:163]
    ds_read_b64_tr_b16 a[20:21], v3 offset:10240
    v_rcp_f32 v207, v191
    v_rcp_f32 v208, v192
    v_rcp_f32_e64 v209, v193
    v_mfma_f32_32x32x16_bf16 v[68:83], a[48:51], v[212:215], v[68:83]
    ds_read_b64_tr_b16 a[22:23], v3 offset:10496
    v_rcp_f32 v210, v194
    v_rcp_f32 v211, v195
    v_exp_f32_e64 v180, v164
    v_mfma_f32_32x32x16_bf16 v[84:99], a[52:55], v[212:215], v[84:99]
    ds_read_b64_tr_b16 a[18:19], v3 offset:8448
    v_exp_f32 v181, v165
    v_exp_f32 v182, v166
    v_exp_f32_e64 v183, v167
    v_mfma_f32_32x32x16_bf16 v[100:115], a[56:59], v[212:215], v[100:115]
    ds_read_b64_tr_b16 a[14:15], v3 offset:6400
    v_exp_f32 v184, v168
    v_exp_f32 v185, v169
    v_mfma_f32_32x32x16_bf16 v[68:83], a[60:63], v[216:219], v[68:83]
    v_exp_f32 v186, v170
    v_exp_f32 v187, v171
    v_exp_f32 v188, v172
    v_exp_f32 v189, v173
    v_mfma_f32_32x32x16_bf16 v[84:99], a[64:67], v[216:219], v[84:99]
    v_exp_f32 v190, v174
    v_exp_f32 v191, v175
    v_exp_f32_e64 v192, v176
    v_mfma_f32_32x32x16_bf16 v[100:115], a[68:71], v[216:219], v[100:115]
    s_waitcnt lgkmcnt(0)
    v_exp_f32 v193, v177
    v_exp_f32 v194, v178
    v_exp_f32 v195, v179
    v_cvt_pk_bf16_f32 v16, v232, v233
    v_cvt_pk_bf16_f32 v17, v234, v235
    v_cvt_pk_bf16_f32 v18, v236, v237
    v_cvt_pk_bf16_f32 v19, v238, v239
    v_pk_fma_f32 v[164:165], v[148:149], v[148:149], s[64:65]
    v_pk_fma_f32 v[166:167], v[150:151], v[150:151], s[64:65]
    v_pk_fma_f32 v[168:169], v[152:153], v[152:153], s[64:65]
    v_pk_fma_f32 v[170:171], v[154:155], v[154:155], s[64:65]
    v_pk_fma_f32 v[172:173], v[156:157], v[156:157], s[64:65]
    v_pk_fma_f32 v[174:175], v[158:159], v[158:159], s[64:65]
    v_pk_fma_f32 v[176:177], v[160:161], v[160:161], s[64:65]
    v_pk_fma_f32 v[178:179], v[162:163], v[162:163], s[64:65]
    v_pk_mul_f32 v[196:197], v[196:197], v[116:117]
    v_pk_mul_f32 v[198:199], v[198:199], v[118:119]
    v_pk_mul_f32 v[200:201], v[200:201], v[120:121]
    v_pk_mul_f32 v[202:203], v[202:203], v[122:123]
    v_pk_mul_f32 v[204:205], v[204:205], v[124:125]
    v_pk_mul_f32 v[206:207], v[206:207], v[126:127]
    v_pk_mul_f32 v[208:209], v[208:209], v[128:129]
    v_pk_mul_f32 v[210:211], v[210:211], v[130:131]
    v_pk_mul_f32 v[164:165], v[164:165], v[148:149] neg_lo:[1,0] neg_hi:[1,0]
    v_pk_mul_f32 v[166:167], v[166:167], v[150:151] neg_lo:[1,0] neg_hi:[1,0]
    v_pk_mul_f32 v[168:169], v[168:169], v[152:153] neg_lo:[1,0] neg_hi:[1,0]
    v_pk_mul_f32 v[170:171], v[170:171], v[154:155] neg_lo:[1,0] neg_hi:[1,0]
    v_pk_mul_f32 v[172:173], v[172:173], v[156:157] neg_lo:[1,0] neg_hi:[1,0]
    v_pk_mul_f32 v[174:175], v[174:175], v[158:159] neg_lo:[1,0] neg_hi:[1,0]
    v_pk_mul_f32 v[176:177], v[176:177], v[160:161] neg_lo:[1,0] neg_hi:[1,0]
    v_pk_mul_f32 v[178:179], v[178:179], v[162:163] neg_lo:[1,0] neg_hi:[1,0]
    v_pk_add_f32 v[180:181], v[180:181], s[66:67]
    v_pk_add_f32 v[182:183], v[182:183], s[66:67]
    v_pk_add_f32 v[184:185], v[184:185], s[66:67]
    v_pk_add_f32 v[186:187], v[186:187], s[66:67]
    v_pk_add_f32 v[188:189], v[188:189], s[66:67]
    v_pk_add_f32 v[190:191], v[190:191], s[66:67]
    v_pk_add_f32 v[192:193], v[192:193], s[66:67]
    v_pk_add_f32 v[194:195], v[194:195], s[66:67]
    v_mfma_f32_32x32x16_bf16 v[116:131], a[192:195], a[196:199], 0
    ds_read_u16 a192, v7 offset:512
    ds_read_b64_tr_b16 a[24:25], v4 offset:24576
    ds_read_b64_tr_b16 a[38:39], v4 offset:29184
    v_cvt_pk_bf16_f32 v212, v196, v197
    v_cvt_pk_bf16_f32 v213, v198, v199
    v_cvt_pk_bf16_f32 v214, v200, v201
    v_cvt_pk_bf16_f32 v215, v202, v203
    v_mfma_f32_32x32x16_bf16 v[116:131], a[0:3], a[72:75], v[116:131]
    ds_read_b64_tr_b16 a[0:1], v3 offset:12288
    ds_read_b64_tr_b16 a[2:3], v3 offset:12544
    ds_read_b64_tr_b16 a[40:41], v4 offset:27712
    v_cvt_pk_bf16_f32 v216, v204, v205
    v_cvt_pk_bf16_f32 v217, v206, v207
    v_cvt_pk_bf16_f32 v218, v208, v209
    v_cvt_pk_bf16_f32 v219, v210, v211
    v_mfma_f32_32x32x16_bf16 v[116:131], a[4:7], a[76:79], v[116:131]
    ds_read_b64_tr_b16 a[4:5], v3 offset:14336
    ds_read_b64_tr_b16 a[6:7], v3 offset:14592
    ds_read_b64_tr_b16 a[42:43], v4 offset:29248
    v_rcp_f32 v196, v180
    v_rcp_f32 v197, v181
    v_mfma_f32_32x32x16_bf16 v[116:131], a[8:11], a[80:83], v[116:131]
    ds_read_b64_tr_b16 a[8:9], v3 offset:16384
    ds_read_b64_tr_b16 a[10:11], v3 offset:16640
    ds_read_b64_tr_b16 a[44:45], v4 offset:27776
    v_rcp_f32 v198, v182
    v_rcp_f32 v199, v183
    v_mfma_f32_32x32x16_bf16 v[116:131], a[12:15], a[84:87], v[116:131]
    ds_read_b64_tr_b16 a[12:13], v3 offset:18432
    ds_read_b64_tr_b16 a[26:27], v4 offset:26112
    ds_read_b64_tr_b16 a[46:47], v4 offset:29312
    v_rcp_f32 v200, v184
    v_rcp_f32 v201, v185
    v_rcp_f32_e64 v202, v186
    v_mfma_f32_32x32x16_bf16 v[116:131], a[16:19], a[88:91], v[116:131]
    ds_read_b64_tr_b16 a[16:17], v3 offset:20480
    ds_read_b64_tr_b16 a[28:29], v4 offset:24640
    v_rcp_f32 v203, v187
    v_rcp_f32 v204, v188
    v_mfma_f32_32x32x16_bf16 v[116:131], a[20:23], a[92:95], v[116:131]
    ds_read_b64_tr_b16 a[20:21], v3 offset:22528
    ds_read_b64_tr_b16 a[30:31], v4 offset:26176
    v_rcp_f32 v205, v189
    v_rcp_f32 v206, v190
    v_rcp_f32_e64 v207, v191
    v_mfma_f32_32x32x16_bf16 v[20:35], a[48:51], v[212:215], v[20:35]
    ds_read_b64_tr_b16 a[22:23], v3 offset:22784
    ds_read_b64_tr_b16 a[32:33], v4 offset:24704
    v_rcp_f32 v208, v192
    v_rcp_f32 v209, v193
    v_mfma_f32_32x32x16_bf16 v[36:51], a[52:55], v[212:215], v[36:51]
    ds_read_b64_tr_b16 a[18:19], v3 offset:20736
    ds_read_b64_tr_b16 a[34:35], v4 offset:26240
    v_rcp_f32 v210, v194
    v_rcp_f32 v211, v195
    v_exp_f32_e64 v180, v164
    v_mfma_f32_32x32x16_bf16 v[52:67], a[56:59], v[212:215], v[52:67]
    ds_read_b64_tr_b16 a[14:15], v3 offset:18688
    ds_read_b64_tr_b16 a[36:37], v4 offset:27648
    v_exp_f32 v181, v165
    v_exp_f32 v182, v166
    v_exp_f32_e64 v183, v167
    v_mfma_f32_32x32x16_bf16 v[20:35], a[60:63], v[216:219], v[20:35]
    v_exp_f32 v184, v168
    v_exp_f32 v185, v169
    v_exp_f32_e64 v186, v170
    v_mfma_f32_32x32x16_bf16 v[36:51], a[64:67], v[216:219], v[36:51]
    v_exp_f32 v187, v171
    v_exp_f32 v188, v172
    v_exp_f32 v189, v173
    v_exp_f32 v190, v174
    v_mfma_f32_32x32x16_bf16 v[52:67], a[68:71], v[216:219], v[52:67]
    s_waitcnt lgkmcnt(0)
    v_exp_f32 v191, v175
    v_exp_f32 v192, v176
    v_exp_f32 v193, v177
    v_exp_f32 v194, v178
    v_exp_f32 v195, v179
    v_pk_fma_f32 v[164:165], v[116:117], v[116:117], s[64:65]
    v_pk_fma_f32 v[166:167], v[118:119], v[118:119], s[64:65]
    v_pk_fma_f32 v[168:169], v[120:121], v[120:121], s[64:65]
    v_pk_fma_f32 v[170:171], v[122:123], v[122:123], s[64:65]
    v_pk_fma_f32 v[172:173], v[124:125], v[124:125], s[64:65]
    v_pk_fma_f32 v[174:175], v[126:127], v[126:127], s[64:65]
    v_pk_fma_f32 v[176:177], v[128:129], v[128:129], s[64:65]
    v_pk_fma_f32 v[178:179], v[130:131], v[130:131], s[64:65]
    v_pk_mul_f32 v[196:197], v[196:197], v[132:133]
    v_pk_mul_f32 v[198:199], v[198:199], v[134:135]
    v_pk_mul_f32 v[200:201], v[200:201], v[136:137]
    v_pk_mul_f32 v[202:203], v[202:203], v[138:139]
    v_pk_mul_f32 v[204:205], v[204:205], v[140:141]
    v_pk_mul_f32 v[206:207], v[206:207], v[142:143]
    v_pk_mul_f32 v[208:209], v[208:209], v[144:145]
    v_pk_mul_f32 v[210:211], v[210:211], v[146:147]
    v_pk_mul_f32 v[164:165], v[164:165], v[116:117] neg_lo:[1,0] neg_hi:[1,0]
    v_pk_mul_f32 v[166:167], v[166:167], v[118:119] neg_lo:[1,0] neg_hi:[1,0]
    v_pk_mul_f32 v[168:169], v[168:169], v[120:121] neg_lo:[1,0] neg_hi:[1,0]
    v_pk_mul_f32 v[170:171], v[170:171], v[122:123] neg_lo:[1,0] neg_hi:[1,0]
    v_pk_mul_f32 v[172:173], v[172:173], v[124:125] neg_lo:[1,0] neg_hi:[1,0]
    v_pk_mul_f32 v[174:175], v[174:175], v[126:127] neg_lo:[1,0] neg_hi:[1,0]
    v_pk_mul_f32 v[176:177], v[176:177], v[128:129] neg_lo:[1,0] neg_hi:[1,0]
    v_pk_mul_f32 v[178:179], v[178:179], v[130:131] neg_lo:[1,0] neg_hi:[1,0]
    v_pk_add_f32 v[180:181], v[180:181], s[66:67]
    v_pk_add_f32 v[182:183], v[182:183], s[66:67]
    v_pk_add_f32 v[184:185], v[184:185], s[66:67]
    v_pk_add_f32 v[186:187], v[186:187], s[66:67]
    v_pk_add_f32 v[188:189], v[188:189], s[66:67]
    v_pk_add_f32 v[190:191], v[190:191], s[66:67]
    v_pk_add_f32 v[192:193], v[192:193], s[66:67]
    v_pk_add_f32 v[194:195], v[194:195], s[66:67]
    v_mfma_f32_32x32x16_bf16 v[132:147], a[192:195], a[196:199], 0
    s_xor_b32 s59, s54, 1
    s_nop 0
    ds_read_u16 a192, v7 offset:640
    v_cvt_pk_bf16_f32 v212, v196, v197
    v_cvt_pk_bf16_f32 v213, v198, v199
    v_cvt_pk_bf16_f32 v214, v200, v201
    v_cvt_pk_bf16_f32 v215, v202, v203
    v_cvt_pk_bf16_f32 v216, v204, v205
    v_cvt_pk_bf16_f32 v217, v206, v207
    v_cvt_pk_bf16_f32 v218, v208, v209
    v_mfma_f32_32x32x16_bf16 v[132:147], a[0:3], a[72:75], v[132:147]
    buffer_load_dwordx4 v[220:223], v10, s[20:23], 0 offen offset:0
    s_mul_i32 s59, s59, 6144
    ds_read_b64_tr_b16 a[0:1], v3 offset:24576
    v_cvt_pk_bf16_f32 v219, v210, v211
    v_rcp_f32 v196, v180
    v_rcp_f32 v197, v181
    v_rcp_f32_e64 v198, v182
    v_mfma_f32_32x32x16_bf16 v[132:147], a[4:7], a[76:79], v[132:147]
    ds_read_b64_tr_b16 a[4:5], v3 offset:26624
    ds_read_b64_tr_b16 a[6:7], v3 offset:26880
    v_rcp_f32 v199, v183
    v_rcp_f32 v200, v184
    v_rcp_f32_e64 v201, v185
    v_mfma_f32_32x32x16_bf16 v[132:147], a[8:11], a[80:83], v[132:147]
    buffer_load_dwordx4 v[224:227], v10, s[20:23], 0 offen offset:64
    ds_read_b64_tr_b16 a[8:9], v3 offset:28672
    v_rcp_f32 v202, v186
    v_rcp_f32 v203, v187
    v_rcp_f32_e64 v204, v188
    v_mfma_f32_32x32x16_bf16 v[132:147], a[12:15], a[84:87], v[132:147]
    ds_read_b64_tr_b16 a[12:13], v3 offset:30720
    ds_read_b64_tr_b16 a[14:15], v3 offset:30976
    v_rcp_f32 v205, v189
    v_rcp_f32 v206, v190
    v_rcp_f32_e64 v207, v191
    v_mfma_f32_32x32x16_bf16 v[132:147], a[16:19], a[88:91], v[132:147]
    buffer_load_dwordx4 v[228:231], v10, s[20:23], 0 offen offset:128
    ds_read_b64_tr_b16 a[16:17], v3 offset:32768
    v_rcp_f32 v208, v192
    v_rcp_f32 v209, v193
    v_rcp_f32_e64 v210, v194
    v_mfma_f32_32x32x16_bf16 v[132:147], a[20:23], a[92:95], v[132:147]
    ds_read_b64_tr_b16 a[20:21], v3 offset:34816
    ds_read_b64_tr_b16 a[18:19], v3 offset:33024
    v_rcp_f32 v211, v195
    v_exp_f32 v180, v164
    v_exp_f32_e64 v181, v165
    v_mfma_f32_32x32x16_bf16 v[68:83], a[24:27], v[212:215], v[68:83]
    buffer_load_dwordx4 v[232:235], v8, s[20:23], 0 offen offset:0
    ds_read_b64_tr_b16 a[10:11], v3 offset:28928
    v_exp_f32 v182, v166
    v_exp_f32 v183, v167
    v_exp_f32_e64 v184, v168
    v_mfma_f32_32x32x16_bf16 v[68:83], a[36:39], v[216:219], v[68:83]
    ds_read_b64_tr_b16 a[22:23], v3 offset:35072
    ds_read_b64_tr_b16 a[2:3], v3 offset:24832
    v_exp_f32 v185, v169
    v_exp_f32 v186, v170
    v_exp_f32_e64 v187, v171
    v_mfma_f32_32x32x16_bf16 v[84:99], a[28:31], v[212:215], v[84:99]
    buffer_load_dwordx4 v[236:239], v8, s[20:23], 0 offen offset:32
    v_exp_f32 v188, v172
    v_exp_f32 v189, v173
    v_exp_f32 v190, v174
    v_exp_f32 v191, v175
    v_mfma_f32_32x32x16_bf16 v[84:99], a[40:43], v[216:219], v[84:99]
    v_exp_f32 v192, v176
    v_exp_f32 v193, v177
    v_exp_f32 v194, v178
    v_exp_f32 v195, v179
    v_mfma_f32_32x32x16_bf16 v[100:115], a[32:35], v[212:215], v[100:115]
    buffer_load_dwordx4 v[240:243], v8, s[20:23], 0 offen offset:64
    v_add_u32_e64 v6, s59, v14
    v_bfe_u32 v4, v1, 4, 1
    v_lshl_add_u32 v4, v4, 6, v12
    v_permlane16_swap_b32 v68, v76
    v_permlane16_swap_b32 v69, v77
    v_mfma_f32_32x32x16_bf16 v[100:115], a[44:47], v[216:219], v[100:115]
    s_waitcnt lgkmcnt(0)
    v_permlane16_swap_b32 v70, v78
    v_permlane16_swap_b32 v71, v79
    v_permlane16_swap_b32 v72, v80
    v_permlane16_swap_b32 v73, v81
    v_permlane16_swap_b32 v74, v82
    v_permlane16_swap_b32 v75, v83
    s_nop 0
    ds_write_b128 v9, v[76:79] offset:0
    v_pk_fma_f32 v[164:165], v[132:133], v[132:133], s[64:65]
    v_pk_fma_f32 v[166:167], v[134:135], v[134:135], s[64:65]
    v_pk_fma_f32 v[168:169], v[136:137], v[136:137], s[64:65]
    v_pk_fma_f32 v[170:171], v[138:139], v[138:139], s[64:65]
    v_pk_fma_f32 v[172:173], v[140:141], v[140:141], s[64:65]
    v_pk_fma_f32 v[174:175], v[142:143], v[142:143], s[64:65]
    v_pk_fma_f32 v[176:177], v[144:145], v[144:145], s[64:65]
    v_pk_fma_f32 v[178:179], v[146:147], v[146:147], s[64:65]
    v_pk_mul_f32 v[196:197], v[196:197], v[148:149]
    v_pk_mul_f32 v[198:199], v[198:199], v[150:151]
    v_pk_mul_f32 v[200:201], v[200:201], v[152:153]
    v_pk_mul_f32 v[202:203], v[202:203], v[154:155]
    v_pk_mul_f32 v[204:205], v[204:205], v[156:157]
    v_pk_mul_f32 v[206:207], v[206:207], v[158:159]
    v_pk_mul_f32 v[208:209], v[208:209], v[160:161]
    v_pk_mul_f32 v[210:211], v[210:211], v[162:163]
    v_pk_mul_f32 v[164:165], v[164:165], v[132:133] neg_lo:[1,0] neg_hi:[1,0]
    v_pk_mul_f32 v[166:167], v[166:167], v[134:135] neg_lo:[1,0] neg_hi:[1,0]
    v_pk_mul_f32 v[168:169], v[168:169], v[136:137] neg_lo:[1,0] neg_hi:[1,0]
    v_pk_mul_f32 v[170:171], v[170:171], v[138:139] neg_lo:[1,0] neg_hi:[1,0]
    v_pk_mul_f32 v[172:173], v[172:173], v[140:141] neg_lo:[1,0] neg_hi:[1,0]
    v_pk_mul_f32 v[174:175], v[174:175], v[142:143] neg_lo:[1,0] neg_hi:[1,0]
    v_pk_mul_f32 v[176:177], v[176:177], v[144:145] neg_lo:[1,0] neg_hi:[1,0]
    v_pk_mul_f32 v[178:179], v[178:179], v[146:147] neg_lo:[1,0] neg_hi:[1,0]
    v_pk_add_f32 v[180:181], v[180:181], s[66:67]
    v_pk_add_f32 v[182:183], v[182:183], s[66:67]
    v_pk_add_f32 v[184:185], v[184:185], s[66:67]
    v_pk_add_f32 v[186:187], v[186:187], s[66:67]
    v_pk_add_f32 v[188:189], v[188:189], s[66:67]
    v_pk_add_f32 v[190:191], v[190:191], s[66:67]
    v_pk_add_f32 v[192:193], v[192:193], s[66:67]
    v_pk_add_f32 v[194:195], v[194:195], s[66:67]
    v_permlane16_swap_b32 v84, v92
    v_permlane16_swap_b32 v85, v93
    v_permlane16_swap_b32 v86, v94
    v_permlane16_swap_b32 v87, v95
    v_permlane16_swap_b32 v88, v96
    v_permlane16_swap_b32 v89, v97
    v_permlane16_swap_b32 v90, v98
    v_permlane16_swap_b32 v91, v99
    ds_write_b128 v9, v[80:83] offset:1024
    v_permlane16_swap_b32 v100, v108
    v_permlane16_swap_b32 v101, v109
    v_permlane16_swap_b32 v102, v110
    v_permlane16_swap_b32 v103, v111
    v_permlane16_swap_b32 v104, v112
    v_permlane16_swap_b32 v105, v113
    v_permlane16_swap_b32 v106, v114
    v_permlane16_swap_b32 v107, v115
    v_mfma_f32_32x32x16_bf16 v[148:163], a[192:195], a[196:199], 0
    ds_write_b128 v9, v[92:95] offset:2048
    v_cvt_pk_bf16_f32 v212, v196, v197
    v_cvt_pk_bf16_f32 v213, v198, v199
    v_cvt_pk_bf16_f32 v214, v200, v201
    v_mfma_f32_32x32x16_bf16 v[148:163], a[0:3], a[72:75], v[148:163]
    ds_write_b128 v9, v[96:99] offset:3072
    v_cvt_pk_bf16_f32 v215, v202, v203
L_pad5:
    s_cbranch_execz L_body
    s_nop 0
    v_cvt_pk_bf16_f32 v216, v204, v205
    v_cvt_pk_bf16_f32 v217, v206, v207
    v_cvt_pk_bf16_f32 v218, v208, v209
    v_mfma_f32_32x32x16_bf16 v[148:163], a[4:7], a[76:79], v[148:163]
    ds_write_b128 v9, v[108:111] offset:4096
    v_cvt_pk_bf16_f32 v219, v210, v211
    v_rcp_f32 v196, v180
    v_rcp_f32 v197, v181
    v_mfma_f32_32x32x16_bf16 v[148:163], a[8:11], a[80:83], v[148:163]
    ds_write_b128 v9, v[112:115] offset:5120
    v_rcp_f32 v198, v182
    v_rcp_f32 v199, v183
    v_mfma_f32_32x32x16_bf16 v[148:163], a[12:15], a[84:87], v[148:163]
    ds_read_b64_tr_b16 a[48:49], v5 offset:0
    ds_read_b64_tr_b16 a[52:53], v5 offset:64
    ds_read_b64_tr_b16 a[58:59], v5 offset:1664
    ds_read_b64_tr_b16 a[68:69], v5 offset:3200
    v_rcp_f32 v200, v184
    v_rcp_f32 v201, v185
    v_mfma_f32_32x32x16_bf16 v[148:163], a[16:19], a[88:91], v[148:163]
    ds_read_b64_tr_b16 a[50:51], v5 offset:1536
    ds_read_b64_tr_b16 a[54:55], v5 offset:1600
    ds_read_b64_tr_b16 a[60:61], v5 offset:3072
    ds_read_b64_tr_b16 a[70:71], v5 offset:4736
    v_rcp_f32 v202, v186
    v_rcp_f32 v203, v187
    v_mfma_f32_32x32x16_bf16 v[148:163], a[20:23], a[92:95], v[148:163]
    ds_read_u16 a216, v0 offset:0
    ds_read_u16 a218, v0 offset:64
    ds_read_u16 a220, v0 offset:128
    buffer_load_dwordx4 v[244:247], v8, s[20:23], 0 offen offset:96
    v_rcp_f32 v204, v188
    v_rcp_f32 v205, v189
    v_rcp_f32_e64 v206, v190
    v_mfma_f32_32x32x16_bf16 v[20:35], a[24:27], v[212:215], v[20:35]
    s_waitcnt lgkmcnt(11)
    s_barrier
    ds_read_b64_tr_b16 a[56:57], v5 offset:128
    ds_read_b64_tr_b16 a[62:63], v5 offset:4608
    v_rcp_f32 v207, v191
    v_rcp_f32 v208, v192
    v_rcp_f32_e64 v209, v193
    v_mfma_f32_32x32x16_bf16 v[36:51], a[28:31], v[212:215], v[36:51]
    ds_read_b128 v[76:79], v6 offset:0
    ds_read_b128 v[80:83], v6 offset:1024
    ds_read_b64_tr_b16 a[64:65], v5 offset:3136
    v_rcp_f32 v210, v194
    v_rcp_f32 v211, v195
    v_exp_f32_e64 v180, v164
    v_mfma_f32_32x32x16_bf16 v[52:67], a[32:35], v[212:215], v[52:67]
    ds_read_b128 v[92:95], v6 offset:2048
    ds_read_b128 v[96:99], v6 offset:3072
    ds_read_b64_tr_b16 a[66:67], v5 offset:4672
    v_exp_f32 v181, v165
    v_exp_f32 v182, v166
    v_exp_f32_e64 v183, v167
    v_mfma_f32_32x32x16_bf16 v[20:35], a[36:39], v[216:219], v[20:35]
    ds_read_b128 v[108:111], v6 offset:4096
    ds_read_b128 v[112:115], v6 offset:5120
    v_exp_f32 v184, v168
    v_exp_f32 v185, v169
    v_exp_f32_e64 v186, v170
    v_mfma_f32_32x32x16_bf16 v[36:51], a[40:43], v[216:219], v[36:51]
    buffer_load_dwordx4 v[248:251], v8, s[20:23], 0 offen offset:128
    v_exp_f32 v187, v171
    v_exp_f32 v188, v172
    v_exp_f32 v189, v173
    v_exp_f32 v190, v174
    v_mfma_f32_32x32x16_bf16 v[52:67], a[44:47], v[216:219], v[52:67]
    buffer_load_dwordx2 v[2:3], v11, s[20:23], 0 offen
    v_exp_f32 v191, v175
    v_exp_f32 v192, v176
    v_exp_f32 v193, v177
    v_exp_f32 v194, v178
    v_exp_f32 v195, v179
    v_add_u32 v7, 32, v8
    v_pk_fma_f32 v[164:165], v[148:149], v[148:149], s[64:65]
    v_pk_fma_f32 v[166:167], v[150:151], v[150:151], s[64:65]
    v_pk_fma_f32 v[168:169], v[152:153], v[152:153], s[64:65]
    v_pk_fma_f32 v[170:171], v[154:155], v[154:155], s[64:65]
    v_pk_fma_f32 v[172:173], v[156:157], v[156:157], s[64:65]
    v_pk_fma_f32 v[174:175], v[158:159], v[158:159], s[64:65]
    v_pk_fma_f32 v[176:177], v[160:161], v[160:161], s[64:65]
    v_pk_fma_f32 v[178:179], v[162:163], v[162:163], s[64:65]
    v_pk_mul_f32 v[196:197], v[196:197], v[116:117]
    v_pk_mul_f32 v[198:199], v[198:199], v[118:119]
    v_pk_mul_f32 v[200:201], v[200:201], v[120:121]
    v_pk_mul_f32 v[202:203], v[202:203], v[122:123]
    v_pk_mul_f32 v[204:205], v[204:205], v[124:125]
    v_pk_mul_f32 v[206:207], v[206:207], v[126:127]
    v_pk_mul_f32 v[208:209], v[208:209], v[128:129]
    v_pk_mul_f32 v[210:211], v[210:211], v[130:131]
    v_pk_mul_f32 v[164:165], v[164:165], v[148:149] neg_lo:[1,0] neg_hi:[1,0]
    v_pk_mul_f32 v[166:167], v[166:167], v[150:151] neg_lo:[1,0] neg_hi:[1,0]
    v_pk_mul_f32 v[168:169], v[168:169], v[152:153] neg_lo:[1,0] neg_hi:[1,0]
    v_pk_mul_f32 v[170:171], v[170:171], v[154:155] neg_lo:[1,0] neg_hi:[1,0]
    v_pk_mul_f32 v[172:173], v[172:173], v[156:157] neg_lo:[1,0] neg_hi:[1,0]
    v_pk_mul_f32 v[174:175], v[174:175], v[158:159] neg_lo:[1,0] neg_hi:[1,0]
    v_pk_mul_f32 v[176:177], v[176:177], v[160:161] neg_lo:[1,0] neg_hi:[1,0]
    v_pk_mul_f32 v[178:179], v[178:179], v[162:163] neg_lo:[1,0] neg_hi:[1,0]
    v_pk_add_f32 v[180:181], v[180:181], s[66:67]
    v_pk_add_f32 v[182:183], v[182:183], s[66:67]
    v_pk_add_f32 v[184:185], v[184:185], s[66:67]
    v_pk_add_f32 v[186:187], v[186:187], s[66:67]
    v_pk_add_f32 v[188:189], v[188:189], s[66:67]
    v_pk_add_f32 v[190:191], v[190:191], s[66:67]
    v_pk_add_f32 v[192:193], v[192:193], s[66:67]
    v_pk_add_f32 v[194:195], v[194:195], s[66:67]
    s_waitcnt lgkmcnt(0)
    s_nop 0
    v_pk_add_f32 v[68:69], v[68:69], v[76:77]
    v_pk_add_f32 v[70:71], v[70:71], v[78:79]
    v_pk_add_f32 v[72:73], v[72:73], v[80:81]
    v_pk_add_f32 v[74:75], v[74:75], v[82:83]
    v_pk_add_f32 v[84:85], v[84:85], v[92:93]
    v_pk_add_f32 v[86:87], v[86:87], v[94:95]
    v_pk_add_f32 v[88:89], v[88:89], v[96:97]
    v_pk_add_f32 v[90:91], v[90:91], v[98:99]
    v_pk_add_f32 v[100:101], v[100:101], v[108:109]
    v_pk_add_f32 v[102:103], v[102:103], v[110:111]
    v_pk_add_f32 v[104:105], v[104:105], v[112:113]
    v_pk_add_f32 v[106:107], v[106:107], v[114:115]
    v_cvt_pk_bf16_f32 v212, v196, v197
    v_cvt_pk_bf16_f32 v213, v198, v199
    v_cvt_pk_bf16_f32 v214, v200, v201
    v_cvt_pk_bf16_f32 v215, v202, v203
    v_cvt_pk_bf16_f32 v216, v204, v205
    v_cvt_pk_bf16_f32 v217, v206, v207
    v_mfma_f32_32x32x16_bf16 v[20:35], a[48:51], v[212:215], v[20:35]
    s_waitcnt vmcnt(6)
    s_nop 0
    ds_read_b128 v[116:119], v4 offset:0
    ds_read_b64_tr_b16 a[176:177], v13 offset:24640
    ds_read_b64_tr_b16 a[178:179], v13 offset:64
    ds_read_b64_tr_b16 a[28:29], v5 offset:12352
    ds_read_b64_tr_b16 a[38:39], v5 offset:16896
    v_cvt_pk_bf16_f32 v218, v208, v209
    v_cvt_pk_bf16_f32 v219, v210, v211
    v_rcp_f32 v196, v180
    v_rcp_f32 v197, v181
    v_rcp_f32_e64 v198, v182
    v_mfma_f32_32x32x16_bf16 v[36:51], a[52:55], v[212:215], v[36:51]
    ds_read_b128 v[120:123], v4 offset:16
    ds_read_b64_tr_b16 a[180:181], v13 offset:24672
    ds_read_b64_tr_b16 a[182:183], v13 offset:96
    ds_read_b64_tr_b16 a[30:31], v5 offset:13888
    ds_read_b64_tr_b16 a[40:41], v5 offset:15424
    v_rcp_f32 v199, v183
    v_rcp_f32 v200, v184
    v_rcp_f32 v201, v185
    v_rcp_f32 v202, v186
    v_mfma_f32_32x32x16_bf16 v[52:67], a[56:59], v[212:215], v[52:67]
    ds_read_b128 v[124:127], v4 offset:128
    ds_read_b64_tr_b16 a[184:185], v13 offset:24704
    ds_read_b64_tr_b16 a[186:187], v13 offset:128
    buffer_load_dwordx4 v[252:255], v8, s[20:23], 0 offen offset:160
    ds_read_b64_tr_b16 a[42:43], v5 offset:16960
    v_rcp_f32 v203, v187
    v_rcp_f32 v204, v188
    v_rcp_f32 v205, v189
    v_rcp_f32 v206, v190
    v_mfma_f32_32x32x16_bf16 v[20:35], a[60:63], v[216:219], v[20:35]
    ds_read_b128 v[128:131], v4 offset:144
    ds_read_b64_tr_b16 a[188:189], v13 offset:24736
    ds_read_b64_tr_b16 a[190:191], v13 offset:160
    ds_read_b64_tr_b16 a[32:33], v5 offset:12416
    ds_read_b64_tr_b16 a[44:45], v5 offset:15488
    v_rcp_f32 v207, v191
    v_rcp_f32 v208, v192
    v_rcp_f32 v209, v193
    v_rcp_f32 v210, v194
    v_mfma_f32_32x32x16_bf16 v[36:51], a[64:67], v[216:219], v[36:51]
    ds_read_b64_tr_b16 a[168:169], v13 offset:24576
    ds_read_b64_tr_b16 a[170:171], v13 offset:0
    ds_read_b64_tr_b16 a[24:25], v5 offset:12288
    ds_read_b64_tr_b16 a[34:35], v5 offset:13952
    ds_read_b64_tr_b16 a[46:47], v5 offset:17024
    v_rcp_f32 v211, v195
    v_exp_f32 v180, v164
    v_exp_f32 v181, v165
    v_exp_f32 v182, v166
    v_mfma_f32_32x32x16_bf16 v[52:67], a[68:71], v[216:219], v[52:67]
    ds_read_b64_tr_b16 a[172:173], v13 offset:24608
    ds_read_b64_tr_b16 a[174:175], v13 offset:32
    ds_read_b64_tr_b16 a[26:27], v5 offset:13824
    ds_read_b64_tr_b16 a[36:37], v5 offset:15360
    v_exp_f32 v183, v167
    v_exp_f32 v184, v168
    v_exp_f32 v185, v169
    v_exp_f32 v186, v170
    v_mfma_f32_32x32x16_bf16 v[20:35], a[216:219], a[196:199], v[20:35]
    v_exp_f32 v187, v171
    v_exp_f32 v188, v172
    v_exp_f32 v189, v173
    v_exp_f32 v190, v174
    v_exp_f32 v191, v175
    v_exp_f32 v192, v176
    v_exp_f32_e64 v193, v177
    v_mfma_f32_32x32x16_bf16 v[36:51], a[218:221], a[196:199], v[36:51]
    v_exp_f32 v194, v178
    v_exp_f32 v195, v179
    v_lshlrev_b32 v76, 16, v220
    v_and_b32 v77, s11, v220
    v_lshlrev_b32 v78, 16, v221
    v_and_b32 v79, s11, v221
    v_lshlrev_b32 v80, 16, v222
    v_and_b32 v81, s11, v222
    v_lshlrev_b32_e64 v82, 16, v223
    v_mfma_f32_32x32x16_bf16 v[52:67], a[220:223], a[196:199], v[52:67]
    s_waitcnt lgkmcnt(0)
    v_and_b32 v83, s11, v223
    v_lshlrev_b32 v92, 16, v224
    v_and_b32 v93, s11, v224
    v_lshlrev_b32 v94, 16, v225
    v_and_b32 v95, s11, v225
    v_lshlrev_b32 v96, 16, v226
    v_and_b32 v97, s11, v226
    v_lshlrev_b32 v98, 16, v227
    v_and_b32 v99, s11, v227
    v_lshlrev_b32 v108, 16, v228
    v_and_b32 v109, s11, v228
    v_lshlrev_b32 v110, 16, v229
    v_and_b32 v111, s11, v229
    v_lshlrev_b32 v112, 16, v230
    v_and_b32 v113, s11, v230
    v_lshlrev_b32 v114, 16, v231
    v_and_b32 v115, s11, v231
    v_pk_mul_f32 v[196:197], v[196:197], v[132:133]
    v_pk_mul_f32 v[198:199], v[198:199], v[134:135]
    v_pk_mul_f32 v[200:201], v[200:201], v[136:137]
    v_pk_mul_f32 v[202:203], v[202:203], v[138:139]
    v_pk_mul_f32 v[204:205], v[204:205], v[140:141]
    v_pk_mul_f32 v[206:207], v[206:207], v[142:143]
    v_pk_mul_f32 v[208:209], v[208:209], v[144:145]
    v_pk_mul_f32 v[210:211], v[210:211], v[146:147]
    v_pk_add_f32 v[180:181], v[180:181], s[66:67]
    v_pk_add_f32 v[182:183], v[182:183], s[66:67]
    v_pk_add_f32 v[184:185], v[184:185], s[66:67]
    v_pk_add_f32 v[186:187], v[186:187], s[66:67]
    v_pk_add_f32 v[188:189], v[188:189], s[66:67]
    v_pk_add_f32 v[190:191], v[190:191], s[66:67]
    v_pk_add_f32 v[192:193], v[192:193], s[66:67]
    v_pk_add_f32 v[194:195], v[194:195], s[66:67]
    v_pk_fma_f32 v[76:77], v[68:69], v[116:117], v[76:77]
    v_pk_fma_f32 v[78:79], v[70:71], v[118:119], v[78:79]
    v_pk_fma_f32 v[80:81], v[72:73], v[120:121], v[80:81]
    v_pk_fma_f32 v[82:83], v[74:75], v[122:123], v[82:83]
    v_pk_fma_f32 v[92:93], v[84:85], v[124:125], v[92:93]
    v_pk_fma_f32 v[94:95], v[86:87], v[126:127], v[94:95]
    v_pk_fma_f32 v[96:97], v[88:89], v[128:129], v[96:97]
    v_pk_fma_f32 v[98:99], v[90:91], v[130:131], v[98:99]
    v_cvt_pk_bf16_f32 v212, v196, v197
    v_cvt_pk_bf16_f32 v213, v198, v199
    v_cvt_pk_bf16_f32 v214, v200, v201
    v_cvt_pk_bf16_f32 v215, v202, v203
    v_cvt_pk_bf16_f32 v216, v204, v205
    v_cvt_pk_bf16_f32 v217, v206, v207
    v_mfma_f32_32x32x16_bf16 v[20:35], a[24:27], v[212:215], v[20:35]
    ds_read_b128 v[164:167], v4 offset:256
    ds_read_b128 v[84:87], v12 offset:64
    ds_read_b128 v[124:127], v12 offset:192
    ds_read_b64_tr_b16 a[96:97], v15 offset:0
    ds_read_b64_tr_b16 a[112:113], v15 offset:128
    ds_read_b64_tr_b16 a[50:51], v5 offset:26112
    ds_read_b64_tr_b16 a[56:57], v5 offset:24704
    ds_read_b64_tr_b16 a[62:63], v5 offset:29184
    ds_read_b64_tr_b16 a[68:69], v5 offset:27776
    v_cvt_pk_bf16_f32 v218, v208, v209
    v_cvt_pk_bf16_f32 v219, v210, v211
    v_cvt_pk_bf16_f32 v220, v76, v77
    v_cvt_pk_bf16_f32 v221, v78, v79
    v_cvt_pk_bf16_f32 v222, v80, v81
    v_cvt_pk_bf16_f32 v223, v82, v83
    v_cvt_pk_bf16_f32 v224, v92, v93
    v_mfma_f32_32x32x16_bf16 v[36:51], a[28:31], v[212:215], v[36:51]
    ds_read_b128 v[168:171], v4 offset:272
    ds_read_b128 v[88:91], v12 offset:80
    ds_read_b128 v[128:131], v12 offset:208
    ds_read_b64_tr_b16 a[100:101], v15 offset:32
    ds_read_b64_tr_b16 a[116:117], v15 offset:160
    ds_read_b64_tr_b16 a[52:53], v5 offset:24640
    ds_read_b64_tr_b16 a[58:59], v5 offset:26240
    ds_read_b64_tr_b16 a[64:65], v5 offset:27712
    ds_read_b64_tr_b16 a[70:71], v5 offset:29312
    v_cvt_pk_bf16_f32 v225, v94, v95
    v_cvt_pk_bf16_f32 v226, v96, v97
    v_cvt_pk_bf16_f32 v227, v98, v99
    v_rcp_f32 v196, v180
    v_rcp_f32 v197, v181
    v_mfma_f32_32x32x16_bf16 v[52:67], a[32:35], v[212:215], v[52:67]
    ds_read_b128 v[68:71], v12 offset:0
    ds_read_b128 v[116:119], v12 offset:128
    ds_read_b128 v[172:175], v12 offset:256
    ds_read_b64_tr_b16 a[104:105], v15 offset:64
    ds_read_b64_tr_b16 a[48:49], v5 offset:24576
    ds_read_b64_tr_b16 a[54:55], v5 offset:26176
    ds_read_b64_tr_b16 a[60:61], v5 offset:27648
    ds_read_b64_tr_b16 a[66:67], v5 offset:29248
    v_rcp_f32 v198, v182
    v_rcp_f32 v199, v183
    v_rcp_f32 v200, v184
    v_rcp_f32 v201, v185
    v_mfma_f32_32x32x16_bf16 v[20:35], a[36:39], v[216:219], v[20:35]
    s_waitcnt vmcnt(0)
    ds_read_b128 v[72:75], v12 offset:16
    ds_read_b128 v[120:123], v12 offset:144
    ds_read_b128 v[176:179], v12 offset:272
    ds_read_b64_tr_b16 a[108:109], v15 offset:96
    buffer_store_dwordx4 v[220:223], v10, s[48:51], 0 offen offset:0 sc1
    v_rcp_f32 v202, v186
    v_rcp_f32 v203, v187
    v_rcp_f32 v204, v188
    v_rcp_f32_e64 v205, v189
    v_mfma_f32_32x32x16_bf16 v[36:51], a[40:43], v[216:219], v[36:51]
    v_rcp_f32 v206, v190
    v_rcp_f32 v207, v191
    v_rcp_f32 v208, v192
    v_rcp_f32 v209, v193
    v_rcp_f32 v210, v194
    v_rcp_f32 v211, v195
    v_lshlrev_b32 v132, 16, v232
    v_and_b32 v133, s11, v232
    v_mfma_f32_32x32x16_bf16 v[52:67], a[44:47], v[216:219], v[52:67]
    s_waitcnt lgkmcnt(0)
    buffer_store_dwordx4 v[224:227], v10, s[48:51], 0 offen offset:64 sc1
    v_lshlrev_b32 v134, 16, v233
    v_and_b32 v135, s11, v233
    v_lshlrev_b32 v136, 16, v234
    v_and_b32 v137, s11, v234
    v_lshlrev_b32 v138, 16, v235
    v_and_b32 v139, s11, v235
    v_lshlrev_b32 v140, 16, v236
    v_and_b32 v141, s11, v236
    v_lshlrev_b32 v142, 16, v237
    v_and_b32 v143, s11, v237
    v_lshlrev_b32 v144, 16, v238
    v_and_b32 v145, s11, v238
    v_lshlrev_b32 v146, 16, v239
    v_and_b32 v147, s11, v239
    v_permlane16_swap_b32 v8, v7
    v_pk_mul_f32 v[196:197], v[196:197], v[148:149]
    v_pk_mul_f32 v[198:199], v[198:199], v[150:151]
    v_pk_mul_f32 v[200:201], v[200:201], v[152:153]
    v_pk_mul_f32 v[202:203], v[202:203], v[154:155]
    v_pk_mul_f32 v[204:205], v[204:205], v[156:157]
    v_pk_mul_f32 v[206:207], v[206:207], v[158:159]
    v_pk_mul_f32 v[208:209], v[208:209], v[160:161]
    v_pk_mul_f32 v[210:211], v[210:211], v[162:163]
    v_pk_fma_f32 v[108:109], v[100:101], v[164:165], v[108:109]
    v_pk_fma_f32 v[110:111], v[102:103], v[166:167], v[110:111]
    v_pk_fma_f32 v[112:113], v[104:105], v[168:169], v[112:113]
    v_pk_fma_f32 v[114:115], v[106:107], v[170:171], v[114:115]
    v_cvt_pk_bf16_f32 v212, v196, v197
    v_cvt_pk_bf16_f32 v213, v198, v199
    v_cvt_pk_bf16_f32 v214, v200, v201
    v_cvt_pk_bf16_f32 v215, v202, v203
    v_cvt_pk_bf16_f32 v216, v204, v205
    v_cvt_pk_bf16_f32 v217, v206, v207
    v_mfma_f32_32x32x16_bf16 v[20:35], a[48:51], v[212:215], v[20:35]
    ds_read_b64_tr_b16 a[120:121], v13 offset:27648
    ds_read_b64_tr_b16 a[128:129], v13 offset:27712
    ds_read_b64_tr_b16 a[140:141], v13 offset:27808
    ds_read_b64_tr_b16 a[134:135], v13 offset:3168
    ds_read_b64_tr_b16 a[4:5], v15 offset:3104
    ds_read_b64_tr_b16 a[20:21], v15 offset:3232
    v_cvt_pk_bf16_f32 v218, v208, v209
    v_cvt_pk_bf16_f32 v219, v210, v211
    v_cvt_pk_bf16_f32 v228, v108, v109
    v_cvt_pk_bf16_f32 v229, v110, v111
    v_cvt_pk_bf16_f32 v230, v112, v113
    v_cvt_pk_bf16_f32 v231, v114, v115
    v_mfma_f32_32x32x16_bf16 v[20:35], a[60:63], v[216:219], v[20:35]
    ds_read_b128 v[196:199], v12 offset:320
    ds_read_b128 v[200:203], v12 offset:336
    ds_read_b64_tr_b16 a[122:123], v13 offset:3072
    ds_read_b64_tr_b16 a[138:139], v13 offset:3200
    ds_read_b64_tr_b16 a[8:9], v15 offset:3136
    v_lshlrev_b32 v148, 16, v240
    v_and_b32 v149, s11, v240
    v_lshlrev_b32 v150, 16, v241
    v_and_b32 v151, s11, v241
    v_lshlrev_b32 v152, 16, v242
    v_and_b32 v153, s11, v242
    v_lshlrev_b32 v154, 16, v243
    v_and_b32 v155, s11, v243
    v_mfma_f32_32x32x16_bf16 v[36:51], a[52:55], v[212:215], v[36:51]
    buffer_store_dwordx4 v[228:231], v10, s[48:51], 0 offen offset:128 sc1
    ds_read_b64_tr_b16 a[132:133], v13 offset:27744
    ds_read_b64_tr_b16 a[126:127], v13 offset:3104
    ds_read_b64_tr_b16 a[142:143], v13 offset:3232
    ds_read_b64_tr_b16 a[12:13], v15 offset:3168
    v_lshlrev_b32 v156, 16, v244
    v_and_b32 v157, s11, v244
    v_lshlrev_b32 v158, 16, v245
    v_and_b32 v159, s11, v245
    v_lshlrev_b32 v160, 16, v246
    v_and_b32 v161, s11, v246
    v_lshlrev_b32_e64 v162, 16, v247
    v_mfma_f32_32x32x16_bf16 v[36:51], a[64:67], v[216:219], v[36:51]
    ds_read_b64_tr_b16 a[124:125], v13 offset:27680
    ds_read_b64_tr_b16 a[136:137], v13 offset:27776
    ds_read_b64_tr_b16 a[130:131], v13 offset:3136
    ds_read_b64_tr_b16 a[0:1], v15 offset:3072
    ds_read_b64_tr_b16 a[16:17], v15 offset:3200
    v_and_b32 v163, s11, v247
    v_lshlrev_b32 v180, 16, v248
    v_and_b32 v181, s11, v248
    v_lshlrev_b32 v182, 16, v249
    v_and_b32_e64 v183, s11, v249
    v_fma_f32 v132, v20, v68, v132
    v_fma_f32 v133, v21, v69, v133
    v_fma_f32 v134, v22, v70, v134
    v_mfma_f32_32x32x16_bf16 v[52:67], a[56:59], v[212:215], v[52:67]
    v_fma_f32 v135, v23, v71, v135
    v_fma_f32 v136, v24, v72, v136
    v_fma_f32 v137, v25, v73, v137
    v_fma_f32 v138, v26, v74, v138
    v_fma_f32 v139, v27, v75, v139
    v_fma_f32 v140, v28, v84, v140
    v_fma_f32 v141, v29, v85, v141
    v_fma_f32 v142, v30, v86, v142
    v_fma_f32 v143, v31, v87, v143
    v_fma_f32 v144, v32, v88, v144
    v_fma_f32 v145, v33, v89, v145
    v_fma_f32 v146, v34, v90, v146
    v_fma_f32 v147, v35, v91, v147
    v_mfma_f32_32x32x16_bf16 v[52:67], a[68:71], v[216:219], v[52:67]
    s_waitcnt lgkmcnt(0)
    s_nop 0
    v_cvt_pk_bf16_f32 v232, v132, v133
    v_cvt_pk_bf16_f32 v233, v134, v135
    v_cvt_pk_bf16_f32 v234, v136, v137
    v_cvt_pk_bf16_f32 v235, v138, v139
    v_cvt_pk_bf16_f32 v236, v140, v141
    v_cvt_pk_bf16_f32 v237, v142, v143
    v_cvt_pk_bf16_f32 v238, v144, v145
    v_cvt_pk_bf16_f32 v239, v146, v147
    v_permlane16_swap_b32 v232, v236
    v_permlane16_swap_b32 v233, v237
    v_permlane16_swap_b32 v234, v238
    v_permlane16_swap_b32 v235, v239
    buffer_store_dwordx4 v[232:235], v8, s[48:51], 0 offen offset:0 sc1
    buffer_store_dwordx4 v[236:239], v7, s[48:51], 0 offen offset:0 sc1
    v_lshlrev_b32 v184, 16, v250
    v_and_b32 v185, s11, v250
    v_lshlrev_b32 v186, 16, v251
    v_and_b32 v187, s11, v251
    v_lshlrev_b32 v188, 16, v252
    v_and_b32 v189, s11, v252
    v_lshlrev_b32 v190, 16, v253
    v_and_b32 v191, s11, v253
    v_lshlrev_b32 v192, 16, v254
    v_and_b32 v193, s11, v254
    v_lshlrev_b32 v194, 16, v255
    v_and_b32 v195, s11, v255
    v_pk_fma_f32 v[148:149], v[36:37], v[116:117], v[148:149]
    v_pk_fma_f32 v[150:151], v[38:39], v[118:119], v[150:151]
    v_pk_fma_f32 v[152:153], v[40:41], v[120:121], v[152:153]
    v_pk_fma_f32 v[154:155], v[42:43], v[122:123], v[154:155]
    v_pk_fma_f32 v[156:157], v[44:45], v[124:125], v[156:157]
    v_pk_fma_f32 v[158:159], v[46:47], v[126:127], v[158:159]
    v_pk_fma_f32 v[160:161], v[48:49], v[128:129], v[160:161]
    v_pk_fma_f32 v[162:163], v[50:51], v[130:131], v[162:163]
    v_cvt_pk_bf16_f32 v240, v148, v149
    v_cvt_pk_bf16_f32 v241, v150, v151
    v_cvt_pk_bf16_f32 v242, v152, v153
    v_cvt_pk_bf16_f32 v243, v154, v155
    v_cvt_pk_bf16_f32 v244, v156, v157
    v_cvt_pk_bf16_f32 v245, v158, v159
    v_cvt_pk_bf16_f32 v246, v160, v161
    v_cvt_pk_bf16_f32 v247, v162, v163
    v_permlane16_swap_b32 v240, v244
    v_permlane16_swap_b32 v241, v245
    v_permlane16_swap_b32 v242, v246
    v_permlane16_swap_b32 v243, v247
    buffer_store_dwordx4 v[240:243], v8, s[48:51], 0 offen offset:64 sc1
    buffer_store_dwordx4 v[244:247], v7, s[48:51], 0 offen offset:64 sc1
    v_pk_fma_f32 v[180:181], v[52:53], v[172:173], v[180:181]
    v_pk_fma_f32 v[182:183], v[54:55], v[174:175], v[182:183]
    v_pk_fma_f32 v[184:185], v[56:57], v[176:177], v[184:185]
    v_pk_fma_f32 v[186:187], v[58:59], v[178:179], v[186:187]
    v_pk_fma_f32 v[188:189], v[60:61], v[196:197], v[188:189]
    v_pk_fma_f32 v[190:191], v[62:63], v[198:199], v[190:191]
    v_pk_fma_f32 v[192:193], v[64:65], v[200:201], v[192:193]
    v_pk_fma_f32 v[194:195], v[66:67], v[202:203], v[194:195]
    v_cvt_pk_bf16_f32 v248, v180, v181
    v_cvt_pk_bf16_f32 v249, v182, v183
    v_cvt_pk_bf16_f32 v250, v184, v185
    v_cvt_pk_bf16_f32 v251, v186, v187
    v_cvt_pk_bf16_f32 v252, v188, v189
    v_cvt_pk_bf16_f32 v253, v190, v191
    v_cvt_pk_bf16_f32 v254, v192, v193
    v_cvt_pk_bf16_f32 v255, v194, v195
    v_permlane16_swap_b32 v248, v252
    v_permlane16_swap_b32 v249, v253
    v_permlane16_swap_b32 v250, v254
    v_permlane16_swap_b32 v251, v255
    v_mfma_f32_16x16x32_bf16 v[84:87], a[168:171], v[16:19], 0
    s_mul_i32 s59, s54, 2176
    v_mov_b32_dpp v68, v16 row_ror:12 row_mask:0xf bank_mask:0xf
    v_mov_b32_dpp v69, v17 row_ror:12 row_mask:0xf bank_mask:0xf
    v_mfma_f32_16x16x32_bf16 v[88:91], a[172:175], v[16:19], 0
    s_lshl_b32 s60, s54, 4
    s_nop 0
    v_mov_b32_dpp v70, v18 row_ror:12 row_mask:0xf bank_mask:0xf
    v_mov_b32_dpp v71, v19 row_ror:12 row_mask:0xf bank_mask:0xf
    v_mfma_f32_16x16x32_bf16 v[92:95], a[176:179], v[16:19], 0
    v_mov_b32_dpp v72, v16 row_ror:8 row_mask:0xf bank_mask:0xf
    v_mov_b32_dpp v73, v17 row_ror:8 row_mask:0xf bank_mask:0xf
    v_mfma_f32_16x16x32_bf16 v[96:99], a[180:183], v[16:19], 0
    buffer_store_dwordx4 v[248:251], v8, s[48:51], 0 offen offset:128 sc1
    v_mov_b32_dpp v74, v18 row_ror:8 row_mask:0xf bank_mask:0xf
    v_mfma_f32_16x16x32_bf16 v[100:103], a[184:187], v[16:19], 0
    v_mov_b32_dpp v75, v19 row_ror:8 row_mask:0xf bank_mask:0xf
    v_mov_b32_dpp v76, v16 row_ror:4 row_mask:0xf bank_mask:0xf
    v_mfma_f32_16x16x32_bf16 v[104:107], a[188:191], v[16:19], 0
    v_mov_b32_dpp v77, v17 row_ror:4 row_mask:0xf bank_mask:0xf
    v_mov_b32_dpp v78, v18 row_ror:4 row_mask:0xf bank_mask:0xf
    v_mfma_f32_16x16x32_bf16 v[84:87], a[120:123], v[68:71], v[84:87]
    v_mov_b32_dpp v79, v19 row_ror:4 row_mask:0xf bank_mask:0xf
    v_min_u32 v149, 23, v1
    v_mfma_f32_16x16x32_bf16 v[88:91], a[124:127], v[68:71], v[88:91]
    v_and_b32 v148, 3, v149
    v_mul_u32_u24 v148, 272, v148
    v_mfma_f32_16x16x32_bf16 v[92:95], a[128:131], v[68:71], v[92:95]
    v_bfe_u32 v150, v149, 2, 2
    v_lshl_add_u32 v148, v150, 6, v148
    v_mfma_f32_16x16x32_bf16 v[96:99], a[132:135], v[68:71], v[96:99]
    buffer_store_dwordx4 v[252:255], v7, s[48:51], 0 offen offset:128 sc1
    v_lshrrev_b32_e64 v150, 4, v149
    v_mfma_f32_16x16x32_bf16 v[100:103], a[136:139], v[68:71], v[100:103]
    v_mul_u32_u24 v150, 1088, v150
    v_add3_u32 v148, v148, v150, s60
    v_mfma_f32_16x16x32_bf16 v[104:107], a[140:143], v[68:71], v[104:107]
    v_lshlrev_b32_e64 v149, 4, v149
    v_add_u32 v149, 162816, v149
    v_mfma_f32_16x16x32_bf16 v[84:87], a[96:99], v[72:75], v[84:87]
    v_lshrrev_b32 v150, 4, v1
    v_add_u32 v150, v150, v1
    v_mfma_f32_16x16x32_bf16 v[88:91], a[100:103], v[72:75], v[88:91]
    v_lshl_add_u32 v150, v150, 4, s59
    v_lshlrev_b32_e64 v140, 16, v2
    v_mfma_f32_16x16x32_bf16 v[92:95], a[104:107], v[72:75], v[92:95]
    v_and_b32 v141, s11, v2
    v_lshlrev_b32 v142, 16, v3
    v_mfma_f32_16x16x32_bf16 v[96:99], a[108:111], v[72:75], v[96:99]
    v_and_b32_e64 v143, s11, v3
    v_mfma_f32_16x16x32_bf16 v[100:103], a[112:115], v[72:75], v[100:103]
    v_mfma_f32_16x16x32_bf16 v[104:107], a[116:119], v[72:75], v[104:107]
    v_mfma_f32_16x16x32_bf16 v[84:87], a[0:3], v[76:79], v[84:87]
    v_mfma_f32_16x16x32_bf16 v[88:91], a[4:7], v[76:79], v[88:91]
    v_mfma_f32_16x16x32_bf16 v[92:95], a[8:11], v[76:79], v[92:95]
    ds_read_b128 v[132:135], v149
    v_mfma_f32_16x16x32_bf16 v[96:99], a[12:15], v[76:79], v[96:99]
    ds_read_b128 v[136:139], v149 offset:384
    v_mfma_f32_16x16x32_bf16 v[100:103], a[16:19], v[76:79], v[100:103]
    v_mfma_f32_16x16x32_bf16 v[104:107], a[20:23], v[76:79], v[104:107]
    s_nop 1
    s_nop 0
    v_mov_b32_dpp v84, v88 row_shr:4 row_mask:0xf bank_mask:0x2
    v_mov_b32_dpp v85, v89 row_shr:4 row_mask:0xf bank_mask:0x2
    v_mov_b32_dpp v86, v90 row_shr:4 row_mask:0xf bank_mask:0x2
    v_mov_b32_dpp v87, v91 row_shr:4 row_mask:0xf bank_mask:0x2
    v_mov_b32_dpp v84, v92 row_shr:8 row_mask:0xf bank_mask:0x4
    v_mov_b32_dpp v85, v93 row_shr:8 row_mask:0xf bank_mask:0x4
    v_mov_b32_dpp v86, v94 row_shr:8 row_mask:0xf bank_mask:0x4
    v_mov_b32_dpp v87, v95 row_shr:8 row_mask:0xf bank_mask:0x4
    v_mov_b32_dpp v84, v96 row_shr:12 row_mask:0xf bank_mask:0x8
    v_mov_b32_dpp v85, v97 row_shr:12 row_mask:0xf bank_mask:0x8
    v_mov_b32_dpp v86, v98 row_shr:12 row_mask:0xf bank_mask:0x8
    v_mov_b32_dpp v87, v99 row_shr:12 row_mask:0xf bank_mask:0x8
    ds_write_b128 v150, v[84:87] offset:24576
    v_mov_b32_dpp v100, v104 row_shr:4 row_mask:0xf bank_mask:0x2
    v_mov_b32_dpp v101, v105 row_shr:4 row_mask:0xf bank_mask:0x2
    v_mov_b32_dpp v102, v106 row_shr:4 row_mask:0xf bank_mask:0x2
    v_mov_b32_dpp v103, v107 row_shr:4 row_mask:0xf bank_mask:0x2
    ds_write_b128 v150, v[100:103] offset:25664
    s_waitcnt lgkmcnt(0)
    s_barrier
    ds_read_b128 v[116:119], v148 offset:24576
    ds_read_b128 v[120:123], v148 offset:26752
    ds_read_b128 v[124:127], v148 offset:28928
    ds_read_b128 v[128:131], v148 offset:31104
    v_pk_add_f32 v[140:141], v[140:141], v[136:137]
    v_pk_add_f32 v[142:143], v[142:143], v[138:139]
    s_waitcnt lgkmcnt(2)
    v_pk_add_f32 v[116:117], v[116:117], v[120:121]
    v_pk_add_f32 v[118:119], v[118:119], v[122:123]
    s_waitcnt lgkmcnt(0)
    v_pk_add_f32 v[124:125], v[124:125], v[128:129]
    v_pk_add_f32 v[126:127], v[126:127], v[130:131]
    v_pk_add_f32 v[116:117], v[116:117], v[124:125]
    v_pk_add_f32 v[118:119], v[118:119], v[126:127]
    v_pk_fma_f32 v[140:141], v[116:117], v[132:133], v[140:141]
    v_pk_fma_f32 v[142:143], v[118:119], v[134:135], v[142:143]
    v_cvt_pk_bf16_f32 v2, v140, v141
    v_cvt_pk_bf16_f32 v3, v142, v143
    buffer_store_dwordx2 v[2:3], v11, s[48:51], 0 offen sc1
L_end:
    s_endpgm
.section .rodata,"a"
.p2align 6
.amdhsa_kernel standalone__modern_conv_block_convnext__vision_kernel
  .amdhsa_next_free_vgpr 512
  .amdhsa_next_free_sgpr 102
  .amdhsa_accum_offset 256
  .amdhsa_group_segment_fixed_size 0
  .amdhsa_kernarg_size 80
  .amdhsa_user_sgpr_count 2
  .amdhsa_user_sgpr_kernarg_segment_ptr 1
  .amdhsa_system_sgpr_workgroup_id_x 1
.end_amdhsa_kernel
```
